```python
import torch

def _softmax(x, axis=-1):
    return torch.softmax(x, dim=axis)
def _gelu(x):
    return torch.nn.functional.gelu(x, approximate="tanh")
def _silu(x):
    return torch.nn.functional.silu(x)
def _sigmoid(x):
    return torch.sigmoid(x)
def _layernorm(x, axis=-1, eps=1e-5):
    m = x.mean(dim=axis, keepdim=True)
    v = x.var(dim=axis, keepdim=True, unbiased=False)
    return (x - m) / torch.sqrt(v + eps)
def _scatter_add(tgt, idx, src, axis=0):
    return tgt.clone().index_add_(axis, idx, src)
def _segment_sum(src, seg, n):
    out = torch.zeros((n,) + src.shape[1:], dtype=src.dtype)
    return out.index_add_(0, seg, src)
def _pad(x, pw):
    flat = tuple(v for pair in reversed(pw) for v in pair)
    return torch.nn.functional.pad(x, flat)

kernel_name = 'concat_heads__linear_attn_block__sliding_block__prompt'

def setup_inputs():

    _w = (lambda a: (lambda t: t.to(torch.bfloat16) if t.is_floating_point() else t)(torch.as_tensor(a)))
    def _A_setup():
        B, S, D = 1, 2048, 512
        return {
            "x": _w((lambda *s: torch.randn(*s, dtype=torch.bfloat16) * 0.05)(B, S, D)),
            "wqkv": _w((lambda *s: torch.randn(*s, dtype=torch.bfloat16) * 0.8)(D, 3 * D)),
            "wo": _w((lambda *s: torch.randn(*s, dtype=torch.bfloat16) * 0.8)(D, D)),
        }
    _A_in = _A_setup()

    def _B_setup():
        B, S, D = 1, 2048, 512
        return {
            "x": _w((lambda *s: torch.randn(*s, dtype=torch.bfloat16) * 0.2)(B, S, D)),
            "wqkv": _w((lambda *s: torch.randn(*s, dtype=torch.bfloat16) * 0.2)(D, 3 * D)),
            "wo": _w((lambda *s: torch.randn(*s, dtype=torch.bfloat16) * 0.05)(D, D)),
        }
    _B_in = _B_setup()

    return {
        "A_x": _A_in["x"],
        "A_wqkv": _A_in["wqkv"],
        "A_wo": _A_in["wo"],
        "B_x": _B_in["x"],
        "B_wqkv": _B_in["wqkv"],
        "B_wo": _B_in["wo"],
    }

def reference(A_x, A_wqkv, A_wo, B_x, B_wqkv, B_wo):
    def _A_ref(x, wqkv, wo):
        B, S, D = x.shape
        H = 32; Dh = D // H
        qkv = (lambda x, *d: x.permute(*d))((x @ wqkv).reshape(B, S, 3, H, Dh), 2, 0, 3, 1, 4)
        q, k, v = qkv[0], qkv[1], qkv[2]
        phi = lambda t: torch.where(t > 0, t + 1, torch.exp(t)) + 1e-6
        pq, pk = phi(q), phi(k)
        kv = torch.einsum("bhsd,bhse->bhde", pk, v)
        z = torch.einsum("bhsd->bhd", pk)
        num = torch.einsum("bhqd,bhde->bhqe", pq, kv)
        den = torch.einsum("bhqd,bhd->bhq", pq, z)[..., None] + 1e-6
        o = num / den
        return (lambda x, *d: x.permute(*d))(o, 0, 2, 1, 3).reshape(B, S, D) @ wo

    def _B_ref(x, wqkv, wo):
        B, S, D = x.shape
        H = 32; Dh = D // H; W = 256
        qkv = (lambda x, *d: x.permute(*d))((x @ wqkv).reshape(B, S, 3, H, Dh), 2, 0, 3, 1, 4)
        q, k, v = qkv[0], qkv[1], qkv[2]
        scores = torch.einsum("bhqd,bhkd->bhqk", q, k) * (Dh ** -0.5)
        idx = torch.arange(S)
        mask = (idx[:, None] - idx[None, :] >= 0) & (idx[:, None] - idx[None, :] < W)
        scores = torch.where(mask[None, None], scores, -1e9)
        p = _softmax(scores, axis=-1)
        o = torch.einsum("bhqk,bhkd->bhqd", p, v)
        return (lambda x, *d: x.permute(*d))(o, 0, 2, 1, 3).reshape(B, S, D) @ wo

    a = _A_ref(A_x, A_wqkv, A_wo)
    b = _B_ref(B_x, B_wqkv, B_wo)
    return torch.concatenate([a, b], axis=-1)
```

```asm
; @launch grid=(256,1,1) block=(512,1,1) lds=163840
.amdgcn_target "amdgcn-amd-amdhsa--gfx950"
.text
.globl concat_heads__linear_attn_block__sliding_block__prompt_kernel
.p2align 8
.type concat_heads__linear_attn_block__sliding_block__prompt_kernel,@function
concat_heads__linear_attn_block__sliding_block__prompt_kernel:
    s_cmp_ge_u32 s2, 256
    s_cbranch_scc1 L_end
    s_load_dwordx16 s[4:19], s[0:1], 0
    s_load_dwordx2 s[20:21], s[0:1], 64
    v_lshrrev_b32 v1, 6, v0
    v_and_b32 v0, 63, v0
    v_readfirstlane_b32 s22, v1
    s_and_b32 s26, s2, 7
    s_lshr_b32 s27, s2, 3
    s_and_b32 s48, s26, 3
    s_lshl_b32 s48, s48, 3
    s_and_b32 s49, s27, 7
    s_add_u32 s23, s48, s49
    s_lshr_b32 s48, s26, 2
    s_lshl_b32 s48, s48, 2
    s_lshr_b32 s49, s27, 3
    s_sub_u32 s49, 3, s49
    s_add_u32 s24, s48, s49
    s_cmp_eq_u32 s22, 3
    s_cbranch_scc0 L_nocpf_1
    s_bfe_u32 s62, s2, 0x30003
    s_cmp_eq_u32 s62, 1
    s_cbranch_scc0 L_nocpf_1
    s_getpc_b64 s[62:63]
L_pc:
    s_and_b32 s62, s62, 0xffffff00
    v_lshlrev_b32 v255, 7, v0
    s_sub_u32 s62, s62, ((L_pc - concat_heads__linear_attn_block__sliding_block__prompt_kernel) & 0xffffff00)
    s_subb_u32 s63, s63, 0
    global_load_dword v254, v255, s[62:63]
    v_add_u32 v255, 8192, v255
    global_load_dword v254, v255, s[62:63]
    v_add_u32 v255, 8192, v255
    global_load_dword v254, v255, s[62:63]
L_nocpf_1:
    s_cmp_lt_u32 s22, 4
    s_cbranch_scc1 L_consumer
    s_sub_u32 s26, s22, 4
    v_lshrrev_b32 v4, 3, v0
    v_and_b32 v5, 7, v0
    v_lshrrev_b32 v6, 1, v4
    v_xor_b32 v7, v5, v6
    v_lshlrev_b32 v7, 4, v7
    s_lshl_b32 s48, s23, 6
    s_lshl_b32 s49, s26, 4
    s_add_u32 s48, s48, s49
    v_add_u32 v1, s48, v4
    v_lshlrev_b32 v1, 10, v1
    v_add_u32 v2, 7168, v1
    v_add_u32 v1, v1, v7
    v_xor_b32 v7, 64, v7
    v_add_u32 v2, v2, v7
    v_add_u32 v3, s49, v4
    v_mul_u32_u24 v3, 3072, v3
    v_and_b32 v6, 2, v4
    v_lshlrev_b32 v6, 1, v6
    v_xor_b32 v6, v5, v6
    v_lshlrev_b32 v6, 4, v6
    s_lshl_b32 s49, s24, 7
    v_add3_u32 v3, v3, v6, s49
    s_lshl_b32 s51, s26, 11
    s_mov_b32 s57, 0
    s_add_u32 s59, s24, s23
    s_and_b32 s59, s59, 3
    s_lshl_b32 s59, s59, 1
    s_waitcnt lgkmcnt(0)
    s_mov_b32 s32, s10
    s_mov_b32 s33, s11
    s_mov_b32 s34, 0x200000
    s_mov_b32 s35, 0x20000
    s_mov_b32 s36, s12
    s_mov_b32 s37, s13
    s_mov_b32 s38, 0x180000
    s_mov_b32 s39, 0x20000
    s_lshl_b32 s52, s59, 7
    s_mul_i32 s53, s59, 196608
    s_mov_b32 m0, s51
    s_add_u32 s54, s53, 23552
    buffer_load_dwordx4 v1, s[32:35], s52 offen lds
    buffer_load_dwordx4 v2, s[32:35], s52 offen offset:1024 lds
    s_add_u32 s55, s51, 8192
    s_mov_b32 m0, s55
    s_nop 0
    buffer_load_dwordx4 v3, s[36:39], s53 offen lds
    buffer_load_dwordx4 v3, s[36:39], s54 offen offset:1024 lds
    s_add_u32 s55, s51, 16384
    s_mov_b32 m0, s55
    s_add_u32 s56, s53, 1024
    buffer_load_dwordx4 v3, s[36:39], s56 offen lds
    s_add_u32 s56, s54, 1024
    buffer_load_dwordx4 v3, s[36:39], s56 offen offset:1024 lds
    s_add_u32 s55, s51, 24576
    s_mov_b32 m0, s55
    s_add_u32 s56, s53, 2048
    buffer_load_dwordx4 v3, s[36:39], s56 offen lds
    s_add_u32 s56, s54, 2048
    buffer_load_dwordx4 v3, s[36:39], s56 offen offset:1024 lds
    s_add_u32 s57, s57, 1
    s_add_u32 s59, s59, 1
    s_and_b32 s59, s59, 7
    s_add_u32 s51, s51, 32768
    s_and_b32 s58, s57, 3
    s_cmp_eq_u32 s58, 0
    s_cbranch_scc0 L_nowrap_2
    s_sub_u32 s51, s51, 131072
L_nowrap_2:
    s_cmp_eq_u32 s57, 8
    s_cbranch_scc0 L_nosw_3
    s_mov_b32 s32, s4
    s_mov_b32 s33, s5
    s_mov_b32 s34, 0x200000
    s_mov_b32 s35, 0x20000
    s_mov_b32 s36, s6
    s_mov_b32 s37, s7
    s_mov_b32 s38, 0x180000
    s_mov_b32 s39, 0x20000
    s_mov_b32 s59, s61
L_nosw_3:
    s_add_u32 s61, s24, s23
    s_and_b32 s61, s61, 3
    s_lshl_b32 s61, s61, 1
    s_lshl_b32 s52, s59, 7
    s_mul_i32 s53, s59, 196608
    s_mov_b32 m0, s51
    s_add_u32 s54, s53, 23552
    buffer_load_dwordx4 v1, s[32:35], s52 offen lds
    buffer_load_dwordx4 v2, s[32:35], s52 offen offset:1024 lds
    s_add_u32 s55, s51, 8192
    s_mov_b32 m0, s55
    s_nop 0
    buffer_load_dwordx4 v3, s[36:39], s53 offen lds
    buffer_load_dwordx4 v3, s[36:39], s54 offen offset:1024 lds
    s_add_u32 s55, s51, 16384
    s_mov_b32 m0, s55
    s_add_u32 s56, s53, 1024
    buffer_load_dwordx4 v3, s[36:39], s56 offen lds
    s_add_u32 s56, s54, 1024
    buffer_load_dwordx4 v3, s[36:39], s56 offen offset:1024 lds
    s_add_u32 s55, s51, 24576
    s_mov_b32 m0, s55
    s_add_u32 s56, s53, 2048
    buffer_load_dwordx4 v3, s[36:39], s56 offen lds
    s_add_u32 s56, s54, 2048
    buffer_load_dwordx4 v3, s[36:39], s56 offen offset:1024 lds
    s_add_u32 s57, s57, 1
    s_add_u32 s59, s59, 1
    s_and_b32 s59, s59, 7
    s_add_u32 s51, s51, 32768
    s_and_b32 s58, s57, 3
    s_cmp_eq_u32 s58, 0
    s_cbranch_scc0 L_nowrap_4
    s_sub_u32 s51, s51, 131072
L_nowrap_4:
    s_cmp_eq_u32 s57, 8
    s_cbranch_scc0 L_nosw_5
    s_mov_b32 s32, s4
    s_mov_b32 s33, s5
    s_mov_b32 s34, 0x200000
    s_mov_b32 s35, 0x20000
    s_mov_b32 s36, s6
    s_mov_b32 s37, s7
    s_mov_b32 s38, 0x180000
    s_mov_b32 s39, 0x20000
    s_mov_b32 s59, s61
L_nosw_5:
    s_mov_b32 s28, s20
    s_mov_b32 s29, s21
    s_mov_b32 s30, 0x10000000
    s_mov_b32 s31, 0x20000
    s_mov_b32 s60, 0
    s_cmp_eq_u32 s26, 3
    s_cbranch_scc0 L_nopf_6
    s_branch L_nopf_6
    s_getpc_b64 s[62:63]
    s_and_b32 s62, s62, 0xffffff00
    v_lshlrev_b32 v8, 7, v0
    s_sub_u32 s62, s62, ((L_pc - concat_heads__linear_attn_block__sliding_block__prompt_kernel) & 0xffffff00)
    s_subb_u32 s63, s63, 0
    global_load_dword v9, v8, s[62:63]
    v_add_u32 v8, 8192, v8
    global_load_dword v10, v8, s[62:63]
    v_add_u32 v8, 8192, v8
    global_load_dword v11, v8, s[62:63]
    s_mov_b32 s60, 1
L_nopf_6:
    s_cmp_ge_u32 s26, 2
    s_cbranch_scc0 L_nopfm_7
    s_cmp_eq_u32 s26, 3
    s_cbranch_scc1 L_pfm7_8
    s_mov_b32 s40, s4
    s_mov_b32 s41, s5
    s_mov_b32 s42, 0x200000
    s_mov_b32 s43, 0x20000
    s_lshl_b32 s62, s2, 13
    v_lshlrev_b32 v8, 7, v0
    buffer_load_dword v9, v8, s[40:43], s62 offen
    s_mov_b32 s60, 2
    s_branch L_nopfm_7
L_pfm7_8:
    s_mov_b32 s40, s6
    s_mov_b32 s41, s7
    s_mov_b32 s42, 0x180000
    s_mov_b32 s43, 0x20000
    s_mul_i32 s62, s2, 6144
    v_min_u32 v8, 47, v0
    v_lshlrev_b32 v8, 7, v8
    buffer_load_dword v9, v8, s[40:43], s62 offen
    s_mov_b32 s60, 2
L_nopfm_7:
    s_and_b32 s86, s22, 1
    s_lshr_b32 s87, s22, 1
    v_lshlrev_b32 v193, 4, v0
    s_lshl_b32 s88, s86, 10
    s_lshl_b32 s89, s87, 13
    s_lshl_b32 s92, s87, 11
    s_add_u32 s93, s89, s88
    v_add_u32 v196, s93, v193
    s_add_u32 s94, s89, 7168
    s_add_u32 s100, s92, 131072
    s_cmp_eq_u32 s86, 0
    s_cselect_b32 s94, s94, s100
    v_add_u32 v197, s94, v193
    s_add_u32 s100, s100, s88
    v_add_u32 v198, s100, v193
    v_lshrrev_b32 v202, 5, v0
    v_lshlrev_b32 v202, 8, v202
    v_and_b32 v203, 15, v0
    v_lshlrev_b32 v203, 4, v203
    v_add_u32 v202, v202, v203
    s_add_u32 s94, s93, 32768
    v_add_u32 v199, s94, v202
    s_add_u32 s94, s89, 39936
    s_add_u32 s100, s92, 139264
    s_cmp_eq_u32 s86, 0
    s_cselect_b32 s94, s94, s100
    v_add_u32 v200, s94, v202
    s_add_u32 s100, s100, s88
    v_add_u32 v201, s100, v202
    v_and_b32 v202, 31, v0
    v_lshrrev_b32 v203, 5, v0
    v_lshlrev_b32 v203, 2, v203
    v_sub_u32 v202, v202, v203
    v_cvt_f32_i32 v202, v202
    v_mov_b32 v203, 0x6e013f39
    v_fmaak_f32 v216, v202, v203, 0x6d813f39
    v_fmaak_f32 v217, v202, v203, 0xed813f39
    v_fmaak_f32 v218, v202, v203, 0xee41ded6
    v_fmaak_f32 v219, v202, v203, 0xeea18f08
    v_fmaak_f32 v220, v202, v203, 0xef72568c
    v_fmaak_f32 v221, v202, v203, 0xef89532d
    v_fmaak_f32 v222, v202, v203, 0xef997b14
    v_fmaak_f32 v223, v202, v203, 0xefa9a2fb
    v_fmaak_f32 v224, v202, v203, 0xeffa6a7f
    v_fmaak_f32 v225, v202, v203, 0xf0054933
    v_fmaak_f32 v226, v202, v203, 0xf00d5d27
    v_fmaak_f32 v227, v202, v203, 0xf015711a
    v_fmaak_f32 v228, v202, v203, 0xf03dd4dc
    v_fmaak_f32 v229, v202, v203, 0xf045e8d0
    v_fmaak_f32 v230, v202, v203, 0xf04dfcc4
    v_fmaak_f32 v231, v202, v203, 0xf05610b7
    v_min_f32 v232, -v216, 0
    v_min_f32 v233, -v217, 0
    v_min_f32 v234, -v218, 0
    v_min_f32 v235, -v219, 0
    v_min_f32 v236, -v220, 0
    v_min_f32 v237, -v221, 0
    v_min_f32 v238, -v222, 0
    v_min_f32 v239, -v223, 0
    v_min_f32 v240, -v224, 0
    v_min_f32 v241, -v225, 0
    v_min_f32 v242, -v226, 0
    v_min_f32 v243, -v227, 0
    v_min_f32 v244, -v228, 0
    v_min_f32 v245, -v229, 0
    v_min_f32 v246, -v230, 0
    v_min_f32 v247, -v231, 0
    v_min_f32 v216, 0, v216
    v_min_f32 v217, 0, v217
    v_min_f32 v218, 0, v218
    v_min_f32 v219, 0, v219
    v_min_f32 v220, 0, v220
    v_min_f32 v221, 0, v221
    v_min_f32 v222, 0, v222
    v_min_f32 v223, 0, v223
    v_min_f32 v224, 0, v224
    v_min_f32 v225, 0, v225
    v_min_f32 v226, 0, v226
    v_min_f32 v227, 0, v227
    v_min_f32 v228, 0, v228
    v_min_f32 v229, 0, v229
    v_min_f32 v230, 0, v230
    v_min_f32 v231, 0, v231
    v_mov_b32 v192, 0xff7fffff
    s_lshl_b32 s87, s24, 13
    s_add_u32 s87, s87, 8486912
    v_lshlrev_b32 v249, 7, v0
    v_add_u32 v249, s87, v249
    s_cmp_eq_u32 s60, 1
    s_cbranch_scc1 L_w7_9
    s_cmp_eq_u32 s60, 2
    s_cbranch_scc0 L_w7c_11
    s_waitcnt vmcnt(9)
    s_branch L_w7b_10
L_w7c_11:
    s_waitcnt vmcnt(8)
    s_branch L_w7b_10
L_w7_9:
    s_waitcnt vmcnt(11)
L_w7b_10:
    s_barrier
    s_lshl_b32 s52, s59, 7
    s_mul_i32 s53, s59, 196608
    s_mov_b32 m0, s51
    s_add_u32 s54, s53, 23552
    buffer_load_dwordx4 v1, s[32:35], s52 offen lds
    buffer_load_dwordx4 v2, s[32:35], s52 offen offset:1024 lds
    s_add_u32 s55, s51, 8192
    s_mov_b32 m0, s55
    s_nop 0
    buffer_load_dwordx4 v3, s[36:39], s53 offen lds
    buffer_load_dwordx4 v3, s[36:39], s54 offen offset:1024 lds
    s_add_u32 s55, s51, 16384
    s_mov_b32 m0, s55
    s_add_u32 s56, s53, 1024
    buffer_load_dwordx4 v3, s[36:39], s56 offen lds
    s_add_u32 s56, s54, 1024
    buffer_load_dwordx4 v3, s[36:39], s56 offen offset:1024 lds
    s_add_u32 s55, s51, 24576
    s_mov_b32 m0, s55
    s_add_u32 s56, s53, 2048
    buffer_load_dwordx4 v3, s[36:39], s56 offen lds
    s_add_u32 s56, s54, 2048
    buffer_load_dwordx4 v3, s[36:39], s56 offen offset:1024 lds
    s_add_u32 s57, s57, 1
    s_add_u32 s59, s59, 1
    s_and_b32 s59, s59, 7
    s_add_u32 s51, s51, 32768
    s_and_b32 s58, s57, 3
    s_cmp_eq_u32 s58, 0
    s_cbranch_scc0 L_nowrap_12
    s_sub_u32 s51, s51, 131072
L_nowrap_12:
    s_cmp_eq_u32 s57, 8
    s_cbranch_scc0 L_nosw_13
    s_mov_b32 s32, s4
    s_mov_b32 s33, s5
    s_mov_b32 s34, 0x200000
    s_mov_b32 s35, 0x20000
    s_mov_b32 s36, s6
    s_mov_b32 s37, s7
    s_mov_b32 s38, 0x180000
    s_mov_b32 s39, 0x20000
    s_mov_b32 s59, s61
L_nosw_13:
    s_cmp_eq_u32 s23, 0
    s_cbranch_scc0 L_nozero_14
    s_cmp_lt_u32 s26, 2
    s_cbranch_scc0 L_nozero_14
    s_lshl_b32 s48, s24, 1
    s_add_u32 s48, s48, s26
    s_lshl_b32 s48, s48, 12
    s_add_u32 s48, s48, 8388608
    v_mov_b32 v12, 0
    v_mov_b32 v13, 0
    v_mov_b32 v14, 0
    v_mov_b32 v15, 0
    v_lshlrev_b32 v8, 4, v0
    buffer_store_dwordx4 v[12:15], v8, s[28:31], s48 offen offset:0 sc1
    buffer_store_dwordx4 v[12:15], v8, s[28:31], s48 offen offset:1024 sc1
    buffer_store_dwordx4 v[12:15], v8, s[28:31], s48 offen offset:2048 sc1
    s_waitcnt vmcnt(3)
L_nozero_14:
    s_mov_b32 s98, 0
    s_mov_b32 s48, 0
L_ldloop_15:
    s_cmp_eq_u32 s48, 7
    s_cbranch_scc1 L_wd_18
    s_branch L_w8_16
    s_cmp_eq_u32 s48, 0
    s_cbranch_scc1 L_w8_16
    s_cmp_eq_u32 s48, 1
    s_cbranch_scc1 L_w9_17
    s_cmp_eq_u32 s48, 12
    s_cbranch_scc1 L_w9_17
    s_waitcnt vmcnt(10)
    s_branch L_wd_18
L_w9_17:
    s_waitcnt vmcnt(9)
    s_branch L_wd_18
L_w8_16:
    s_waitcnt vmcnt(8)
L_wd_18:
    s_barrier
    s_cmp_eq_u32 s48, 7
    s_cbranch_scc0 L_nonn_19
    v_mov_b32 v8, 155648
    ds_read_b32 v9, v8
    s_waitcnt lgkmcnt(0)
    v_readfirstlane_b32 s25, v9
L_nonn_19:
    s_cmp_eq_u32 s48, 9
    s_cbranch_scc0 L_nosig2_20
    s_cmp_eq_u32 s26, 0
    s_cbranch_scc0 L_nosig2_20
    s_lshl_b32 s49, s24, 12
    s_lshl_b32 s50, s23, 7
    s_add_u32 s49, s49, s50
    s_add_u32 s49, s49, 8454144
    v_mov_b32 v250, s25
    v_mov_b32 v251, 0
    s_mov_b64 exec, 1
    buffer_store_dword v250, v251, s[28:31], s49 offen sc1
    s_mov_b64 exec, -1
L_nosig2_20:
    s_lshl_b32 s52, s59, 7
    s_mul_i32 s53, s59, 196608
    s_mov_b32 m0, s51
    s_add_u32 s54, s53, 23552
    buffer_load_dwordx4 v1, s[32:35], s52 offen lds
    buffer_load_dwordx4 v2, s[32:35], s52 offen offset:1024 lds
    s_add_u32 s55, s51, 8192
    s_mov_b32 m0, s55
    s_nop 0
    buffer_load_dwordx4 v3, s[36:39], s53 offen lds
    buffer_load_dwordx4 v3, s[36:39], s54 offen offset:1024 lds
    s_add_u32 s55, s51, 16384
    s_mov_b32 m0, s55
    s_add_u32 s56, s53, 1024
    buffer_load_dwordx4 v3, s[36:39], s56 offen lds
    s_add_u32 s56, s54, 1024
    buffer_load_dwordx4 v3, s[36:39], s56 offen offset:1024 lds
    s_add_u32 s55, s51, 24576
    s_mov_b32 m0, s55
    s_add_u32 s56, s53, 2048
    buffer_load_dwordx4 v3, s[36:39], s56 offen lds
    s_add_u32 s56, s54, 2048
    buffer_load_dwordx4 v3, s[36:39], s56 offen offset:1024 lds
    s_add_u32 s57, s57, 1
    s_add_u32 s59, s59, 1
    s_and_b32 s59, s59, 7
    s_add_u32 s51, s51, 32768
    s_and_b32 s58, s57, 3
    s_cmp_eq_u32 s58, 0
    s_cbranch_scc0 L_nowrap_21
    s_sub_u32 s51, s51, 131072
L_nowrap_21:
    s_cmp_eq_u32 s57, 8
    s_cbranch_scc0 L_nosw_22
    s_mov_b32 s32, s4
    s_mov_b32 s33, s5
    s_mov_b32 s34, 0x200000
    s_mov_b32 s35, 0x20000
    s_mov_b32 s36, s6
    s_mov_b32 s37, s7
    s_mov_b32 s38, 0x180000
    s_mov_b32 s39, 0x20000
    s_mov_b32 s59, s61
L_nosw_22:
    s_cmp_eq_u32 s48, 7
    s_cbranch_scc0 L_nosig_23
    s_waitcnt vmcnt(16)
    s_barrier
L_nosig_23:
    s_add_u32 s48, s48, 1
    s_cmp_lt_u32 s48, 12
    s_cbranch_scc1 L_ldloop_15
    s_sub_u32 s48, s23, 4
    v_add_u32 v8, s48, v0
    v_max_i32 v8, 0, v8
    v_cmp_gt_u32 vcc, 4, v0
    s_lshl_b32 s49, s24, 12
    s_add_u32 s49, s49, 8454144
    v_cndmask_b32 v8, 0, v8, vcc
    v_lshlrev_b32 v8, 7, v8
    v_add_u32 v8, s49, v8
    s_cmp_eq_u32 s26, 0
    s_cselect_b32 s62, 31, 15
    s_mov_b32 s63, 0
    s_waitcnt vmcnt(8)
    s_barrier
    s_mov_b64 exec, s[62:63]
    buffer_load_dword v9, v8, s[28:31], 0 offen sc1
    s_mov_b64 exec, -1
    s_lshl_b32 s52, s59, 7
    s_mul_i32 s53, s59, 196608
    s_mov_b32 m0, s51
    s_add_u32 s54, s53, 23552
    buffer_load_dwordx4 v1, s[32:35], s52 offen lds
    buffer_load_dwordx4 v2, s[32:35], s52 offen offset:1024 lds
    s_add_u32 s55, s51, 8192
    s_mov_b32 m0, s55
    s_nop 0
    buffer_load_dwordx4 v3, s[36:39], s53 offen lds
    buffer_load_dwordx4 v3, s[36:39], s54 offen offset:1024 lds
    s_add_u32 s55, s51, 16384
    s_mov_b32 m0, s55
    s_add_u32 s56, s53, 1024
    buffer_load_dwordx4 v3, s[36:39], s56 offen lds
    s_add_u32 s56, s54, 1024
    buffer_load_dwordx4 v3, s[36:39], s56 offen offset:1024 lds
    s_add_u32 s55, s51, 24576
    s_mov_b32 m0, s55
    s_add_u32 s56, s53, 2048
    buffer_load_dwordx4 v3, s[36:39], s56 offen lds
    s_add_u32 s56, s54, 2048
    buffer_load_dwordx4 v3, s[36:39], s56 offen offset:1024 lds
    s_add_u32 s57, s57, 1
    s_add_u32 s59, s59, 1
    s_and_b32 s59, s59, 7
    s_add_u32 s51, s51, 32768
    s_and_b32 s58, s57, 3
    s_cmp_eq_u32 s58, 0
    s_cbranch_scc0 L_nowrap_24
    s_sub_u32 s51, s51, 131072
L_nowrap_24:
    s_cmp_eq_u32 s57, 8
    s_cbranch_scc0 L_nosw_25
    s_mov_b32 s32, s4
    s_mov_b32 s33, s5
    s_mov_b32 s34, 0x200000
    s_mov_b32 s35, 0x20000
    s_mov_b32 s36, s6
    s_mov_b32 s37, s7
    s_mov_b32 s38, 0x180000
    s_mov_b32 s39, 0x20000
    s_mov_b32 s59, s61
L_nosw_25:
    s_waitcnt vmcnt(9)
    s_barrier
    s_mov_b64 exec, s[62:63]
    s_waitcnt vmcnt(8)
    v_cmp_ne_u32 vcc, s25, v9
    s_nop 1
    s_cbranch_vccz L_f1b_ok_27
    s_mov_b32 s60, 0
L_f1b_poll_28:
    buffer_load_dword v9, v8, s[28:31], 0 offen sc1
L_f1b_chk_30:
    s_add_u32 s60, s60, 1
    s_cmp_gt_u32 s60, 2000000
    s_cbranch_scc1 L_f1b_done_29
    s_waitcnt vmcnt(0)
    v_cmp_ne_u32 vcc, s25, v9
    s_nop 1
    s_cbranch_vccz L_f1b_done_29
    s_sleep 1
    s_branch L_f1b_poll_28
L_f1b_done_29:
    s_waitcnt vmcnt(0)
L_f1b_ok_27:
    s_mov_b64 exec, -1
    s_cmp_eq_u32 s23, 0
    s_cbranch_scc1 L_norem_31
    v_lshlrev_b32 v8, 4, v0
    s_lshl_b32 s48, s24, 2
    s_add_u32 s48, s48, s26
    s_lshl_b32 s48, s48, 6
    s_lshl_b32 s49, s23, 1
    s_sub_u32 s49, s49, 8
    s_lshl_b32 s52, s26, 13
    s_add_i32 s50, s49, 0
    s_max_i32 s50, s50, 0
    s_add_u32 s50, s50, s48
    s_lshl_b32 s50, s50, 10
    s_add_u32 s51, s52, 0
    s_mov_b32 m0, s51
    s_nop 0
    buffer_load_dwordx4 v8, s[28:31], s50 offen sc1 lds
    s_add_i32 s50, s49, 1
    s_max_i32 s50, s50, 0
    s_add_u32 s50, s50, s48
    s_lshl_b32 s50, s50, 10
    s_add_u32 s51, s52, 1024
    s_mov_b32 m0, s51
    s_nop 0
    buffer_load_dwordx4 v8, s[28:31], s50 offen sc1 lds
    s_add_i32 s50, s49, 2
    s_max_i32 s50, s50, 0
    s_add_u32 s50, s50, s48
    s_lshl_b32 s50, s50, 10
    s_add_u32 s51, s52, 2048
    s_mov_b32 m0, s51
    s_nop 0
    buffer_load_dwordx4 v8, s[28:31], s50 offen sc1 lds
    s_add_i32 s50, s49, 3
    s_max_i32 s50, s50, 0
    s_add_u32 s50, s50, s48
    s_lshl_b32 s50, s50, 10
    s_add_u32 s51, s52, 3072
    s_mov_b32 m0, s51
    s_nop 0
    buffer_load_dwordx4 v8, s[28:31], s50 offen sc1 lds
    s_add_i32 s50, s49, 4
    s_max_i32 s50, s50, 0
    s_add_u32 s50, s50, s48
    s_lshl_b32 s50, s50, 10
    s_add_u32 s51, s52, 4096
    s_mov_b32 m0, s51
    s_nop 0
    buffer_load_dwordx4 v8, s[28:31], s50 offen sc1 lds
    s_add_i32 s50, s49, 5
    s_max_i32 s50, s50, 0
    s_add_u32 s50, s50, s48
    s_lshl_b32 s50, s50, 10
    s_add_u32 s51, s52, 5120
    s_mov_b32 m0, s51
    s_nop 0
    buffer_load_dwordx4 v8, s[28:31], s50 offen sc1 lds
    s_add_i32 s50, s49, 6
    s_max_i32 s50, s50, 0
    s_add_u32 s50, s50, s48
    s_lshl_b32 s50, s50, 10
    s_add_u32 s51, s52, 6144
    s_mov_b32 m0, s51
    s_nop 0
    buffer_load_dwordx4 v8, s[28:31], s50 offen sc1 lds
    s_add_i32 s50, s49, 7
    s_max_i32 s50, s50, 0
    s_add_u32 s50, s50, s48
    s_lshl_b32 s50, s50, 10
    s_add_u32 s51, s52, 7168
    s_mov_b32 m0, s51
    s_nop 0
    buffer_load_dwordx4 v8, s[28:31], s50 offen sc1 lds
    s_add_i32 s50, s49, 0
    s_max_i32 s50, s50, 0
    s_add_u32 s50, s50, s48
    s_lshl_b32 s50, s50, 10
    s_add_u32 s86, s50, 2097152
    s_add_i32 s50, s49, 1
    s_max_i32 s50, s50, 0
    s_add_u32 s50, s50, s48
    s_lshl_b32 s50, s50, 10
    s_add_u32 s87, s50, 2097152
    s_add_i32 s50, s49, 2
    s_max_i32 s50, s50, 0
    s_add_u32 s50, s50, s48
    s_lshl_b32 s50, s50, 10
    s_add_u32 s88, s50, 2097152
    s_add_i32 s50, s49, 3
    s_max_i32 s50, s50, 0
    s_add_u32 s50, s50, s48
    s_lshl_b32 s50, s50, 10
    s_add_u32 s89, s50, 2097152
    s_add_i32 s50, s49, 4
    s_max_i32 s50, s50, 0
    s_add_u32 s50, s50, s48
    s_lshl_b32 s50, s50, 10
    s_add_u32 s92, s50, 2097152
    s_add_i32 s50, s49, 5
    s_max_i32 s50, s50, 0
    s_add_u32 s50, s50, s48
    s_lshl_b32 s50, s50, 10
    s_add_u32 s93, s50, 2097152
    s_add_i32 s50, s49, 6
    s_max_i32 s50, s50, 0
    s_add_u32 s50, s50, s48
    s_lshl_b32 s50, s50, 10
    s_add_u32 s94, s50, 2097152
    s_add_i32 s50, s49, 7
    s_max_i32 s50, s50, 0
    s_add_u32 s50, s50, s48
    s_lshl_b32 s50, s50, 10
    s_add_u32 s100, s50, 2097152
    s_add_u32 s51, s52, 32768
    s_waitcnt vmcnt(8)
    s_barrier
    s_mov_b32 m0, s51
    s_add_u32 s51, s51, 1024
    buffer_load_dwordx4 v8, s[28:31], s86 offen sc1 lds
    s_mov_b32 m0, s51
    s_add_u32 s51, s51, 1024
    buffer_load_dwordx4 v8, s[28:31], s87 offen sc1 lds
    s_mov_b32 m0, s51
    s_add_u32 s51, s51, 1024
    buffer_load_dwordx4 v8, s[28:31], s88 offen sc1 lds
    s_mov_b32 m0, s51
    s_add_u32 s51, s51, 1024
    buffer_load_dwordx4 v8, s[28:31], s89 offen sc1 lds
    s_mov_b32 m0, s51
    s_add_u32 s51, s51, 1024
    buffer_load_dwordx4 v8, s[28:31], s92 offen sc1 lds
    s_mov_b32 m0, s51
    s_add_u32 s51, s51, 1024
    buffer_load_dwordx4 v8, s[28:31], s93 offen sc1 lds
    s_mov_b32 m0, s51
    s_add_u32 s51, s51, 1024
    buffer_load_dwordx4 v8, s[28:31], s94 offen sc1 lds
    s_mov_b32 m0, s51
    s_add_u32 s51, s51, 1024
    buffer_load_dwordx4 v8, s[28:31], s100 offen sc1 lds
    s_barrier
    s_waitcnt vmcnt(0)
    s_branch L_remj_32
L_norem_31:
    s_waitcnt vmcnt(0)
    s_barrier
    s_barrier
L_remj_32:
    s_waitcnt lgkmcnt(0)
    s_barrier
    s_branch L_attn
L_consumer:
    s_waitcnt lgkmcnt(0)
    s_mov_b32 s28, s20
    s_mov_b32 s29, s21
    s_mov_b32 s30, 0x10000000
    s_mov_b32 s31, 0x20000
    s_mov_b32 s40, s18
    s_mov_b32 s41, s19
    s_mov_b32 s42, 0x100
    s_mov_b32 s43, 0x20000
    s_or_b32 s58, s2, s22
    s_cmp_eq_u32 s58, 0
    s_cbranch_scc0 L_nononce_33
    s_memrealtime s[58:59]
    v_mov_b32 v2, 0
    s_waitcnt lgkmcnt(0)
    s_or_b32 s58, s58, 1
    v_mov_b32 v3, s58
    buffer_store_dword v3, v2, s[40:43], 0 offen sc1
L_nononce_33:
    s_mov_b32 s32, s6
    s_mov_b32 s33, s7
    s_mov_b32 s34, 0x180000
    s_mov_b32 s35, 0x20000
    s_and_b32 s27, s22, 1
    v_and_b32 v1, 31, v0
    v_lshrrev_b32 v2, 5, v0
    v_bfe_u32 v3, v0, 1, 3
    v_xor_b32 v3, v3, v2
    v_lshlrev_b32 v3, 4, v3
    v_lshlrev_b32 v1, 7, v1
    v_add_u32 v136, v1, v3
    v_xor_b32 v137, 32, v136
    v_xor_b32 v138, 64, v136
    v_xor_b32 v139, 96, v136
    v_bfe_u32 v1, v0, 2, 2
    v_and_b32 v2, 3, v0
    v_bfe_u32 v3, v0, 4, 1
    v_lshrrev_b32 v4, 5, v0
    v_lshlrev_b32 v4, 3, v4
    v_add_u32 v4, v4, v1
    v_lshlrev_b32 v4, 7, v4
    v_lshlrev_b32 v3, 1, v3
    v_lshrrev_b32 v5, 1, v2
    v_add_u32 v3, v3, v5
    s_lshl_b32 s48, s27, 2
    v_add_u32 v3, s48, v3
    v_and_b32 v5, 2, v1
    v_lshlrev_b32 v5, 1, v5
    v_xor_b32 v3, v3, v5
    v_lshlrev_b32 v3, 4, v3
    v_and_b32 v2, 1, v2
    v_lshlrev_b32 v2, 3, v2
    v_add3_u32 v4, v4, v3, v2
    v_add_u32 v140, 8192, v4
    s_and_b32 s86, s22, 1
    s_lshr_b32 s87, s22, 1
    v_lshlrev_b32 v193, 4, v0
    s_lshl_b32 s88, s86, 10
    s_lshl_b32 s89, s87, 13
    s_lshl_b32 s92, s87, 11
    s_add_u32 s93, s89, s88
    v_add_u32 v196, s93, v193
    s_add_u32 s94, s89, 7168
    s_add_u32 s100, s92, 131072
    s_cmp_eq_u32 s86, 0
    s_cselect_b32 s94, s94, s100
    v_add_u32 v197, s94, v193
    s_add_u32 s100, s100, s88
    v_add_u32 v198, s100, v193
    v_lshrrev_b32 v202, 5, v0
    v_lshlrev_b32 v202, 8, v202
    v_and_b32 v203, 15, v0
    v_lshlrev_b32 v203, 4, v203
    v_add_u32 v202, v202, v203
    s_add_u32 s94, s93, 32768
    v_add_u32 v199, s94, v202
    s_add_u32 s94, s89, 39936
    s_add_u32 s100, s92, 139264
    s_cmp_eq_u32 s86, 0
    s_cselect_b32 s94, s94, s100
    v_add_u32 v200, s94, v202
    s_add_u32 s100, s100, s88
    v_add_u32 v201, s100, v202
    v_and_b32 v202, 31, v0
    v_lshrrev_b32 v203, 5, v0
    v_lshlrev_b32 v203, 2, v203
    v_sub_u32 v202, v202, v203
    v_cvt_f32_i32 v202, v202
    v_mov_b32 v203, 0x6e013f39
    v_fmaak_f32 v216, v202, v203, 0x6d813f39
    v_fmaak_f32 v217, v202, v203, 0xed813f39
    v_fmaak_f32 v218, v202, v203, 0xee41ded6
    v_fmaak_f32 v219, v202, v203, 0xeea18f08
    v_fmaak_f32 v220, v202, v203, 0xef72568c
    v_fmaak_f32 v221, v202, v203, 0xef89532d
    v_fmaak_f32 v222, v202, v203, 0xef997b14
    v_fmaak_f32 v223, v202, v203, 0xefa9a2fb
    v_fmaak_f32 v224, v202, v203, 0xeffa6a7f
    v_fmaak_f32 v225, v202, v203, 0xf0054933
    v_fmaak_f32 v226, v202, v203, 0xf00d5d27
    v_fmaak_f32 v227, v202, v203, 0xf015711a
    v_fmaak_f32 v228, v202, v203, 0xf03dd4dc
    v_fmaak_f32 v229, v202, v203, 0xf045e8d0
    v_fmaak_f32 v230, v202, v203, 0xf04dfcc4
    v_fmaak_f32 v231, v202, v203, 0xf05610b7
    v_min_f32 v232, -v216, 0
    v_min_f32 v233, -v217, 0
    v_min_f32 v234, -v218, 0
    v_min_f32 v235, -v219, 0
    v_min_f32 v236, -v220, 0
    v_min_f32 v237, -v221, 0
    v_min_f32 v238, -v222, 0
    v_min_f32 v239, -v223, 0
    v_min_f32 v240, -v224, 0
    v_min_f32 v241, -v225, 0
    v_min_f32 v242, -v226, 0
    v_min_f32 v243, -v227, 0
    v_min_f32 v244, -v228, 0
    v_min_f32 v245, -v229, 0
    v_min_f32 v246, -v230, 0
    v_min_f32 v247, -v231, 0
    v_min_f32 v216, 0, v216
    v_min_f32 v217, 0, v217
    v_min_f32 v218, 0, v218
    v_min_f32 v219, 0, v219
    v_min_f32 v220, 0, v220
    v_min_f32 v221, 0, v221
    v_min_f32 v222, 0, v222
    v_min_f32 v223, 0, v223
    v_min_f32 v224, 0, v224
    v_min_f32 v225, 0, v225
    v_min_f32 v226, 0, v226
    v_min_f32 v227, 0, v227
    v_min_f32 v228, 0, v228
    v_min_f32 v229, 0, v229
    v_min_f32 v230, 0, v230
    v_min_f32 v231, 0, v231
    v_mov_b32 v192, 0xff7fffff
    s_lshl_b32 s87, s24, 13
    s_add_u32 s87, s87, 8486912
    v_lshlrev_b32 v249, 7, v0
    v_add_u32 v249, s87, v249
    s_mov_b32 s49, 0
    s_mov_b32 s69, 32768
    s_cmp_ge_u32 s22, 2
    s_cbranch_scc1 L_qwave
    s_lshl_b32 s52, s24, 13
    s_lshl_b32 s53, s23, 1
    s_add_u32 s53, s53, s22
    s_lshl_b32 s53, s53, 7
    s_add_u32 s52, s52, s53
    s_add_u32 s52, s52, 8486912
    v_mov_b32 v254, 0
    s_mov_b64 exec, 1
    buffer_load_dword v255, v254, s[28:31], s52 offen sc1
    s_lshr_b32 s52, s23, 1
    s_lshl_b32 s52, s52, 11
    s_and_b32 s53, s23, 1
    s_lshl_b32 s53, s53, 3
    s_add_u32 s53, s53, s24
    s_lshl_b32 s53, s53, 7
    s_add_u32 s52, s52, s53
    s_add_u32 s52, s52, 8552448
    s_lshl_b32 s53, s24, 12
    s_lshl_b32 s54, s23, 7
    s_add_u32 s53, s53, s54
    s_add_u32 s53, s53, 8454144
    s_cmp_eq_u32 s22, 0
    s_cselect_b32 s52, s52, s53
    buffer_load_dword v255, v254, s[28:31], s52 offen sc1
    s_mov_b64 exec, -1
    s_barrier
    ds_read_b128 v[72:75], v136 offset:0
    ds_read_b128 v[76:79], v136 offset:4096
    ds_read_b64_tr_b16 v[80:81], v140 offset:8192
    ds_read_b64_tr_b16 v[82:83], v140 offset:8704
    ds_read_b64_tr_b16 v[84:85], v140 offset:16384
    ds_read_b64_tr_b16 v[86:87], v140 offset:16896
    ds_read_b128 v[88:91], v137 offset:0
    ds_read_b128 v[92:95], v137 offset:4096
    ds_read_b64_tr_b16 v[96:97], v140 offset:10240
    ds_read_b64_tr_b16 v[98:99], v140 offset:10752
    ds_read_b64_tr_b16 v[100:101], v140 offset:18432
    ds_read_b64_tr_b16 v[102:103], v140 offset:18944
    s_mov_b32 s48, 0
    s_waitcnt lgkmcnt(6)
    v_mfma_f32_32x32x16_bf16 v[8:23], v[80:83], v[72:75], 0
    ds_read_b128 v[104:107], v138 offset:0
    ds_read_b128 v[108:111], v138 offset:4096
    v_mfma_f32_32x32x16_bf16 v[24:39], v[80:83], v[76:79], 0
    ds_read_b64_tr_b16 v[112:113], v140 offset:12288
    ds_read_b64_tr_b16 v[114:115], v140 offset:12800
    v_mfma_f32_32x32x16_bf16 v[40:55], v[72:75], v[84:87], 0
    ds_read_b64_tr_b16 v[116:117], v140 offset:20480
    ds_read_b64_tr_b16 v[118:119], v140 offset:20992
    v_mfma_f32_32x32x16_bf16 v[56:71], v[76:79], v[84:87], 0
L_ckvB_34:
    s_add_u32 s49, s49, 1
    s_and_b32 s50, s49, 3
    s_cmp_eq_u32 s50, 0
    s_cselect_b32 s50, 0xfffe8000, s69
    s_waitcnt lgkmcnt(6)
    v_mfma_f32_32x32x16_bf16 v[8:23], v[96:99], v[88:91], v[8:23]
    ds_read_b128 v[120:123], v139 offset:0
    ds_read_b128 v[124:127], v139 offset:4096
    v_mfma_f32_32x32x16_bf16 v[24:39], v[96:99], v[92:95], v[24:39]
    ds_read_b64_tr_b16 v[128:129], v140 offset:14336
    ds_read_b64_tr_b16 v[130:131], v140 offset:14848
    v_mfma_f32_32x32x16_bf16 v[40:55], v[88:91], v[100:103], v[40:55]
    ds_read_b64_tr_b16 v[132:133], v140 offset:22528
    ds_read_b64_tr_b16 v[134:135], v140 offset:23040
    v_mfma_f32_32x32x16_bf16 v[56:71], v[92:95], v[100:103], v[56:71]
    v_add_u32 v136, s50, v136
    v_add_u32 v137, s50, v137
    v_add_u32 v138, s50, v138
    v_add_u32 v139, s50, v139
    v_add_u32 v140, s50, v140
    s_barrier
    s_cmp_lt_u32 s48, 7
    s_cbranch_scc0 L_cxkvB_35
    s_waitcnt lgkmcnt(6)
    v_mfma_f32_32x32x16_bf16 v[8:23], v[112:115], v[104:107], v[8:23]
    ds_read_b128 v[72:75], v136 offset:0
    ds_read_b128 v[76:79], v136 offset:4096
    v_mfma_f32_32x32x16_bf16 v[24:39], v[112:115], v[108:111], v[24:39]
    ds_read_b64_tr_b16 v[80:81], v140 offset:8192
    ds_read_b64_tr_b16 v[82:83], v140 offset:8704
    v_mfma_f32_32x32x16_bf16 v[40:55], v[104:107], v[116:119], v[40:55]
    ds_read_b64_tr_b16 v[84:85], v140 offset:16384
    ds_read_b64_tr_b16 v[86:87], v140 offset:16896
    v_mfma_f32_32x32x16_bf16 v[56:71], v[108:111], v[116:119], v[56:71]
    s_waitcnt lgkmcnt(6)
    v_mfma_f32_32x32x16_bf16 v[8:23], v[128:131], v[120:123], v[8:23]
    ds_read_b128 v[88:91], v137 offset:0
    ds_read_b128 v[92:95], v137 offset:4096
    v_mfma_f32_32x32x16_bf16 v[24:39], v[128:131], v[124:127], v[24:39]
    ds_read_b64_tr_b16 v[96:97], v140 offset:10240
    ds_read_b64_tr_b16 v[98:99], v140 offset:10752
    v_mfma_f32_32x32x16_bf16 v[40:55], v[120:123], v[132:135], v[40:55]
    ds_read_b64_tr_b16 v[100:101], v140 offset:18432
    ds_read_b64_tr_b16 v[102:103], v140 offset:18944
    v_mfma_f32_32x32x16_bf16 v[56:71], v[124:127], v[132:135], v[56:71]
    s_add_u32 s48, s48, 1
    s_waitcnt lgkmcnt(6)
    v_mfma_f32_32x32x16_bf16 v[8:23], v[80:83], v[72:75], v[8:23]
    ds_read_b128 v[104:107], v138 offset:0
    ds_read_b128 v[108:111], v138 offset:4096
    v_mfma_f32_32x32x16_bf16 v[24:39], v[80:83], v[76:79], v[24:39]
    ds_read_b64_tr_b16 v[112:113], v140 offset:12288
    ds_read_b64_tr_b16 v[114:115], v140 offset:12800
    v_mfma_f32_32x32x16_bf16 v[40:55], v[72:75], v[84:87], v[40:55]
    ds_read_b64_tr_b16 v[116:117], v140 offset:20480
    ds_read_b64_tr_b16 v[118:119], v140 offset:20992
    v_mfma_f32_32x32x16_bf16 v[56:71], v[76:79], v[84:87], v[56:71]
    s_branch L_ckvB_34
L_cxkvB_35:
    s_waitcnt lgkmcnt(6)
    v_mfma_f32_32x32x16_bf16 v[8:23], v[112:115], v[104:107], v[8:23]
    v_mfma_f32_32x32x16_bf16 v[24:39], v[112:115], v[108:111], v[24:39]
    v_mfma_f32_32x32x16_bf16 v[40:55], v[104:107], v[116:119], v[40:55]
    v_mfma_f32_32x32x16_bf16 v[56:71], v[108:111], v[116:119], v[56:71]
    s_waitcnt lgkmcnt(0)
    v_mfma_f32_32x32x16_bf16 v[8:23], v[128:131], v[120:123], v[8:23]
    v_mfma_f32_32x32x16_bf16 v[24:39], v[128:131], v[124:127], v[24:39]
    v_mfma_f32_32x32x16_bf16 v[40:55], v[120:123], v[132:135], v[40:55]
    v_mfma_f32_32x32x16_bf16 v[56:71], v[124:127], v[132:135], v[56:71]
    v_mov_b32 v2, 155648
    ds_read_b32 v3, v2
    s_waitcnt lgkmcnt(0)
    v_readfirstlane_b32 s25, v3
    s_lshl_b32 s62, s24, 2
    s_lshl_b32 s63, s27, 1
    s_add_u32 s62, s62, s63
    s_lshl_b32 s62, s62, 6
    s_lshl_b32 s63, s23, 1
    s_add_u32 s62, s62, s63
    s_lshl_b32 s62, s62, 10
    v_lshlrev_b32 v1, 4, v0
    s_lshl_b32 s63, s27, 12
    s_add_u32 s63, s63, 131072
    v_add_u32 v4, s63, v1
    v_bfe_u32 v2, v0, 4, 1
    v_lshrrev_b32 v3, 5, v0
    v_lshlrev_b32 v3, 8, v3
    v_and_b32 v5, 15, v0
    v_lshlrev_b32 v5, 4, v5
    v_add_u32 v3, v3, v5
    v_lshlrev_b32 v5, 11, v2
    v_add_u32 v5, v5, v3
    s_add_u32 s63, s63, 8192
    v_add_u32 v5, s63, v5
    v_lshlrev_b32 v2, 16, v2
    v_add_u32 v2, v2, v3
    s_add_u32 s64, s62, 65536
    s_add_u32 s65, s62, 2097152
    s_nop 3
    v_cvt_pk_bf16_f32 v144, v8, v9
    v_cvt_pk_bf16_f32 v145, v10, v11
    v_cvt_pk_bf16_f32 v146, v12, v13
    v_cvt_pk_bf16_f32 v147, v14, v15
    v_cvt_pk_bf16_f32 v148, v16, v17
    v_cvt_pk_bf16_f32 v149, v18, v19
    v_cvt_pk_bf16_f32 v150, v20, v21
    v_cvt_pk_bf16_f32 v151, v22, v23
    v_cvt_pk_bf16_f32 v152, v40, v41
    v_cvt_pk_bf16_f32 v153, v42, v43
    v_cvt_pk_bf16_f32 v154, v44, v45
    v_cvt_pk_bf16_f32 v155, v46, v47
    v_cvt_pk_bf16_f32 v156, v48, v49
    v_cvt_pk_bf16_f32 v157, v50, v51
    v_cvt_pk_bf16_f32 v158, v52, v53
    v_cvt_pk_bf16_f32 v159, v54, v55
    buffer_store_dwordx4 v[144:147], v1, s[28:31], s62 offen offset:0 sc1
    buffer_store_dwordx4 v[148:151], v1, s[28:31], s64 offen offset:0 sc1
    buffer_store_dwordx4 v[152:155], v2, s[28:31], s65 offen offset:0 sc1
    buffer_store_dwordx4 v[156:159], v2, s[28:31], s65 offen offset:512 sc1
    ds_write_b128 v4, v[144:147] offset:0
    ds_write_b128 v4, v[148:151] offset:2048
    ds_write_b128 v5, v[152:155] offset:0
    ds_write_b128 v5, v[156:159] offset:512
    v_cvt_pk_bf16_f32 v160, v24, v25
    v_cvt_pk_bf16_f32 v161, v26, v27
    v_cvt_pk_bf16_f32 v162, v28, v29
    v_cvt_pk_bf16_f32 v163, v30, v31
    v_cvt_pk_bf16_f32 v164, v32, v33
    v_cvt_pk_bf16_f32 v165, v34, v35
    v_cvt_pk_bf16_f32 v166, v36, v37
    v_cvt_pk_bf16_f32 v167, v38, v39
    v_cvt_pk_bf16_f32 v168, v56, v57
    v_cvt_pk_bf16_f32 v169, v58, v59
    v_cvt_pk_bf16_f32 v170, v60, v61
    v_cvt_pk_bf16_f32 v171, v62, v63
    v_cvt_pk_bf16_f32 v172, v64, v65
    v_cvt_pk_bf16_f32 v173, v66, v67
    v_cvt_pk_bf16_f32 v174, v68, v69
    v_cvt_pk_bf16_f32 v175, v70, v71
    buffer_store_dwordx4 v[160:163], v1, s[28:31], s62 offen offset:1024 sc1
    buffer_store_dwordx4 v[164:167], v1, s[28:31], s64 offen offset:1024 sc1
    buffer_store_dwordx4 v[168:171], v2, s[28:31], s65 offen offset:1024 sc1
    buffer_store_dwordx4 v[172:175], v2, s[28:31], s65 offen offset:1536 sc1
    ds_write_b128 v4, v[160:163] offset:1024
    ds_write_b128 v4, v[164:167] offset:3072
    ds_write_b128 v5, v[168:171] offset:1024
    ds_write_b128 v5, v[172:175] offset:1536
    s_barrier
    ds_read_b128 v[72:75], v136 offset:0
    ds_read_b128 v[76:79], v136 offset:4096
    ds_read_b64_tr_b16 v[80:81], v140 offset:8192
    ds_read_b64_tr_b16 v[82:83], v140 offset:8704
    ds_read_b64_tr_b16 v[84:85], v140 offset:16384
    ds_read_b64_tr_b16 v[86:87], v140 offset:16896
    ds_read_b128 v[88:91], v137 offset:0
    ds_read_b128 v[92:95], v137 offset:4096
    ds_read_b64_tr_b16 v[96:97], v140 offset:10240
    ds_read_b64_tr_b16 v[98:99], v140 offset:10752
    ds_read_b64_tr_b16 v[100:101], v140 offset:18432
    ds_read_b64_tr_b16 v[102:103], v140 offset:18944
    s_mov_b32 s48, 0
    s_waitcnt lgkmcnt(6)
    v_mfma_f32_32x32x16_bf16 v[8:23], v[72:75], v[80:83], 0
    ds_read_b128 v[104:107], v138 offset:0
    ds_read_b128 v[108:111], v138 offset:4096
    v_mfma_f32_32x32x16_bf16 v[24:39], v[76:79], v[80:83], 0
    ds_read_b64_tr_b16 v[112:113], v140 offset:12288
    ds_read_b64_tr_b16 v[114:115], v140 offset:12800
    v_mfma_f32_32x32x16_bf16 v[40:55], v[72:75], v[84:87], 0
    ds_read_b64_tr_b16 v[116:117], v140 offset:20480
    ds_read_b64_tr_b16 v[118:119], v140 offset:20992
    v_mfma_f32_32x32x16_bf16 v[56:71], v[76:79], v[84:87], 0
L_ckvA_36:
    s_add_u32 s49, s49, 1
    s_and_b32 s50, s49, 3
    s_cmp_eq_u32 s50, 0
    s_cselect_b32 s50, 0xfffe8000, s69
    s_waitcnt lgkmcnt(6)
    v_mfma_f32_32x32x16_bf16 v[8:23], v[88:91], v[96:99], v[8:23]
    ds_read_b128 v[120:123], v139 offset:0
    ds_read_b128 v[124:127], v139 offset:4096
    v_mfma_f32_32x32x16_bf16 v[24:39], v[92:95], v[96:99], v[24:39]
    ds_read_b64_tr_b16 v[128:129], v140 offset:14336
    ds_read_b64_tr_b16 v[130:131], v140 offset:14848
    v_mfma_f32_32x32x16_bf16 v[40:55], v[88:91], v[100:103], v[40:55]
    ds_read_b64_tr_b16 v[132:133], v140 offset:22528
    ds_read_b64_tr_b16 v[134:135], v140 offset:23040
    v_mfma_f32_32x32x16_bf16 v[56:71], v[92:95], v[100:103], v[56:71]
    s_cmp_eq_u32 s48, 1
    s_cbranch_scc0 L_novm_38
    s_waitcnt vmcnt(0)
L_novm_38:
    v_add_u32 v136, s50, v136
    v_add_u32 v137, s50, v137
    v_add_u32 v138, s50, v138
    v_add_u32 v139, s50, v139
    v_add_u32 v140, s50, v140
    s_barrier
    s_cmp_lt_u32 s48, 7
    s_cbranch_scc0 L_cxkvA_37
    s_waitcnt lgkmcnt(6)
    v_mfma_f32_32x32x16_bf16 v[8:23], v[104:107], v[112:115], v[8:23]
    ds_read_b128 v[72:75], v136 offset:0
    ds_read_b128 v[76:79], v136 offset:4096
    v_mfma_f32_32x32x16_bf16 v[24:39], v[108:111], v[112:115], v[24:39]
    ds_read_b64_tr_b16 v[80:81], v140 offset:8192
    ds_read_b64_tr_b16 v[82:83], v140 offset:8704
    v_mfma_f32_32x32x16_bf16 v[40:55], v[104:107], v[116:119], v[40:55]
    ds_read_b64_tr_b16 v[84:85], v140 offset:16384
    ds_read_b64_tr_b16 v[86:87], v140 offset:16896
    v_mfma_f32_32x32x16_bf16 v[56:71], v[108:111], v[116:119], v[56:71]
    s_waitcnt lgkmcnt(6)
    v_mfma_f32_32x32x16_bf16 v[8:23], v[120:123], v[128:131], v[8:23]
    ds_read_b128 v[88:91], v137 offset:0
    ds_read_b128 v[92:95], v137 offset:4096
    v_mfma_f32_32x32x16_bf16 v[24:39], v[124:127], v[128:131], v[24:39]
    ds_read_b64_tr_b16 v[96:97], v140 offset:10240
    ds_read_b64_tr_b16 v[98:99], v140 offset:10752
    v_mfma_f32_32x32x16_bf16 v[40:55], v[120:123], v[132:135], v[40:55]
    ds_read_b64_tr_b16 v[100:101], v140 offset:18432
    ds_read_b64_tr_b16 v[102:103], v140 offset:18944
    v_mfma_f32_32x32x16_bf16 v[56:71], v[124:127], v[132:135], v[56:71]
    s_add_u32 s48, s48, 1
    s_waitcnt lgkmcnt(6)
    v_mfma_f32_32x32x16_bf16 v[8:23], v[72:75], v[80:83], v[8:23]
    ds_read_b128 v[104:107], v138 offset:0
    ds_read_b128 v[108:111], v138 offset:4096
    v_mfma_f32_32x32x16_bf16 v[24:39], v[76:79], v[80:83], v[24:39]
    ds_read_b64_tr_b16 v[112:113], v140 offset:12288
    ds_read_b64_tr_b16 v[114:115], v140 offset:12800
    v_mfma_f32_32x32x16_bf16 v[40:55], v[72:75], v[84:87], v[40:55]
    ds_read_b64_tr_b16 v[116:117], v140 offset:20480
    ds_read_b64_tr_b16 v[118:119], v140 offset:20992
    v_mfma_f32_32x32x16_bf16 v[56:71], v[76:79], v[84:87], v[56:71]
    s_branch L_ckvA_36
L_cxkvA_37:
    s_waitcnt lgkmcnt(6)
    v_mfma_f32_32x32x16_bf16 v[8:23], v[104:107], v[112:115], v[8:23]
    v_mfma_f32_32x32x16_bf16 v[24:39], v[108:111], v[112:115], v[24:39]
    v_mfma_f32_32x32x16_bf16 v[40:55], v[104:107], v[116:119], v[40:55]
    v_mfma_f32_32x32x16_bf16 v[56:71], v[108:111], v[116:119], v[56:71]
    s_waitcnt lgkmcnt(0)
    v_mfma_f32_32x32x16_bf16 v[8:23], v[120:123], v[128:131], v[8:23]
    v_mfma_f32_32x32x16_bf16 v[24:39], v[124:127], v[128:131], v[24:39]
    v_mfma_f32_32x32x16_bf16 v[40:55], v[120:123], v[132:135], v[40:55]
    v_mfma_f32_32x32x16_bf16 v[56:71], v[124:127], v[132:135], v[56:71]
    s_waitcnt lgkmcnt(0)
    s_setprio 2
    s_mov_b32 s61, 0x3fb8aa3b
    s_mov_b32 s62, 0x358637bd
    s_mov_b32 s63, s62
    s_mov_b32 s66, s61
    s_mov_b32 s67, s61
    v_mov_b32 v112, 0x3f803f80
    v_mov_b32 v113, 0x3f803f80
    v_mov_b32 v114, 0x3f803f80
    v_mov_b32 v115, 0x3f803f80
    s_nop 4
    v_cvt_pk_bf16_f32 v96, v40, v41
    v_cvt_pk_bf16_f32 v97, v42, v43
    v_cvt_pk_bf16_f32 v98, v44, v45
    v_cvt_pk_bf16_f32 v99, v46, v47
    v_cvt_pk_bf16_f32 v100, v48, v49
    v_cvt_pk_bf16_f32 v101, v50, v51
    v_cvt_pk_bf16_f32 v102, v52, v53
    v_cvt_pk_bf16_f32 v103, v54, v55
    v_cvt_pk_bf16_f32 v104, v56, v57
    v_cvt_pk_bf16_f32 v105, v58, v59
    v_cvt_pk_bf16_f32 v106, v60, v61
    v_cvt_pk_bf16_f32 v107, v62, v63
    v_cvt_pk_bf16_f32 v108, v64, v65
    v_cvt_pk_bf16_f32 v109, v66, v67
    v_cvt_pk_bf16_f32 v110, v68, v69
    v_cvt_pk_bf16_f32 v111, v70, v71
    v_pk_mul_f32 v[72:73], v[8:9], s[66:67]
    v_pk_mul_f32 v[74:75], v[10:11], s[66:67]
    v_pk_mul_f32 v[76:77], v[12:13], s[66:67]
    v_pk_mul_f32 v[78:79], v[14:15], s[66:67]
    v_exp_f32 v72, v72 clamp
    v_exp_f32 v73, v73 clamp
    v_exp_f32 v74, v74 clamp
    v_exp_f32 v75, v75 clamp
    v_exp_f32 v76, v76 clamp
    v_exp_f32 v77, v77 clamp
    v_exp_f32 v78, v78 clamp
    v_exp_f32 v79, v79 clamp
    v_max_f32 v8, 0, v8
    v_max_f32 v9, 0, v9
    v_max_f32 v10, 0, v10
    v_max_f32 v11, 0, v11
    v_max_f32 v12, 0, v12
    v_max_f32 v13, 0, v13
    v_max_f32 v14, 0, v14
    v_max_f32 v15, 0, v15
    v_pk_add_f32 v[8:9], v[8:9], s[62:63]
    v_pk_add_f32 v[10:11], v[10:11], s[62:63]
    v_pk_add_f32 v[12:13], v[12:13], s[62:63]
    v_pk_add_f32 v[14:15], v[14:15], s[62:63]
    v_pk_add_f32 v[8:9], v[8:9], v[72:73]
    v_pk_add_f32 v[10:11], v[10:11], v[74:75]
    v_pk_add_f32 v[12:13], v[12:13], v[76:77]
    v_pk_add_f32 v[14:15], v[14:15], v[78:79]
    v_pk_mul_f32 v[72:73], v[16:17], s[66:67]
    v_pk_mul_f32 v[74:75], v[18:19], s[66:67]
    v_pk_mul_f32 v[76:77], v[20:21], s[66:67]
    v_pk_mul_f32 v[78:79], v[22:23], s[66:67]
    v_exp_f32 v72, v72 clamp
    v_exp_f32 v73, v73 clamp
    v_exp_f32 v74, v74 clamp
    v_exp_f32 v75, v75 clamp
    v_exp_f32 v76, v76 clamp
    v_exp_f32 v77, v77 clamp
    v_exp_f32 v78, v78 clamp
    v_exp_f32 v79, v79 clamp
    v_max_f32 v16, 0, v16
    v_max_f32 v17, 0, v17
    v_max_f32 v18, 0, v18
    v_max_f32 v19, 0, v19
    v_max_f32 v20, 0, v20
    v_max_f32 v21, 0, v21
    v_max_f32 v22, 0, v22
    v_max_f32 v23, 0, v23
    v_pk_add_f32 v[16:17], v[16:17], s[62:63]
    v_pk_add_f32 v[18:19], v[18:19], s[62:63]
    v_pk_add_f32 v[20:21], v[20:21], s[62:63]
    v_pk_add_f32 v[22:23], v[22:23], s[62:63]
    v_pk_add_f32 v[16:17], v[16:17], v[72:73]
    v_pk_add_f32 v[18:19], v[18:19], v[74:75]
    v_pk_add_f32 v[20:21], v[20:21], v[76:77]
    v_pk_add_f32 v[22:23], v[22:23], v[78:79]
    v_cvt_pk_bf16_f32 v80, v8, v9
    v_cvt_pk_bf16_f32 v81, v10, v11
    v_cvt_pk_bf16_f32 v82, v12, v13
    v_cvt_pk_bf16_f32 v83, v14, v15
    v_cvt_pk_bf16_f32 v84, v16, v17
    v_cvt_pk_bf16_f32 v85, v18, v19
    v_cvt_pk_bf16_f32 v86, v20, v21
    v_cvt_pk_bf16_f32 v87, v22, v23
    s_nop 1
    v_mfma_f32_32x32x16_bf16 v[40:55], v[80:83], v[96:99], 0
    v_mfma_f32_32x32x16_bf16 v[56:71], v[112:115], v[80:83], 0
    v_mfma_f32_32x32x16_bf16 v[40:55], v[84:87], v[100:103], v[40:55]
    v_mfma_f32_32x32x16_bf16 v[56:71], v[112:115], v[84:87], v[56:71]
    s_barrier
    v_pk_mul_f32 v[72:73], v[24:25], s[66:67]
    v_pk_mul_f32 v[74:75], v[26:27], s[66:67]
    v_pk_mul_f32 v[76:77], v[28:29], s[66:67]
    v_pk_mul_f32 v[78:79], v[30:31], s[66:67]
    v_exp_f32 v72, v72 clamp
    v_exp_f32 v73, v73 clamp
    v_exp_f32 v74, v74 clamp
    v_exp_f32 v75, v75 clamp
    v_exp_f32 v76, v76 clamp
    v_exp_f32 v77, v77 clamp
    v_exp_f32 v78, v78 clamp
    v_exp_f32 v79, v79 clamp
    v_max_f32 v24, 0, v24
    v_max_f32 v25, 0, v25
    v_max_f32 v26, 0, v26
    v_max_f32 v27, 0, v27
    v_max_f32 v28, 0, v28
    v_max_f32 v29, 0, v29
    v_max_f32 v30, 0, v30
    v_max_f32 v31, 0, v31
    v_pk_add_f32 v[24:25], v[24:25], s[62:63]
    v_pk_add_f32 v[26:27], v[26:27], s[62:63]
    v_pk_add_f32 v[28:29], v[28:29], s[62:63]
    v_pk_add_f32 v[30:31], v[30:31], s[62:63]
    v_pk_add_f32 v[24:25], v[24:25], v[72:73]
    v_pk_add_f32 v[26:27], v[26:27], v[74:75]
    v_pk_add_f32 v[28:29], v[28:29], v[76:77]
    v_pk_add_f32 v[30:31], v[30:31], v[78:79]
    v_pk_mul_f32 v[72:73], v[32:33], s[66:67]
    v_pk_mul_f32 v[74:75], v[34:35], s[66:67]
    v_pk_mul_f32 v[76:77], v[36:37], s[66:67]
    v_pk_mul_f32 v[78:79], v[38:39], s[66:67]
    v_exp_f32 v72, v72 clamp
    v_exp_f32 v73, v73 clamp
    v_exp_f32 v74, v74 clamp
    v_exp_f32 v75, v75 clamp
    v_exp_f32 v76, v76 clamp
    v_exp_f32 v77, v77 clamp
    v_exp_f32 v78, v78 clamp
    v_exp_f32 v79, v79 clamp
    v_max_f32 v32, 0, v32
    v_max_f32 v33, 0, v33
    v_max_f32 v34, 0, v34
    v_max_f32 v35, 0, v35
    v_max_f32 v36, 0, v36
    v_max_f32 v37, 0, v37
    v_max_f32 v38, 0, v38
    v_max_f32 v39, 0, v39
    v_pk_add_f32 v[32:33], v[32:33], s[62:63]
    v_pk_add_f32 v[34:35], v[34:35], s[62:63]
    v_pk_add_f32 v[36:37], v[36:37], s[62:63]
    v_pk_add_f32 v[38:39], v[38:39], s[62:63]
    v_pk_add_f32 v[32:33], v[32:33], v[72:73]
    v_pk_add_f32 v[34:35], v[34:35], v[74:75]
    v_pk_add_f32 v[36:37], v[36:37], v[76:77]
    v_pk_add_f32 v[38:39], v[38:39], v[78:79]
    v_cvt_pk_bf16_f32 v88, v24, v25
    v_cvt_pk_bf16_f32 v89, v26, v27
    v_cvt_pk_bf16_f32 v90, v28, v29
    v_cvt_pk_bf16_f32 v91, v30, v31
    v_cvt_pk_bf16_f32 v92, v32, v33
    v_cvt_pk_bf16_f32 v93, v34, v35
    v_cvt_pk_bf16_f32 v94, v36, v37
    v_cvt_pk_bf16_f32 v95, v38, v39
    s_nop 1
    v_mfma_f32_32x32x16_bf16 v[40:55], v[88:91], v[104:107], v[40:55]
    v_mfma_f32_32x32x16_bf16 v[56:71], v[112:115], v[88:91], v[56:71]
    v_mfma_f32_32x32x16_bf16 v[40:55], v[92:95], v[108:111], v[40:55]
    v_mfma_f32_32x32x16_bf16 v[56:71], v[112:115], v[92:95], v[56:71]
    s_mov_b32 s64, 0xffff0000
    s_mov_b32 s65, 0xffff0000
    s_lshl_b32 s63, s24, 1
    s_add_u32 s63, s63, s27
    s_lshl_b32 s63, s63, 12
    s_add_u32 s63, s63, 8388608
    v_lshlrev_b32 v3, 2, v0
    v_bfe_i32 v4, v0, 4, 1
    s_nop 4
    v_bfi_b32 v120, v4, v48, v40
    v_bfi_b32 v121, v4, v49, v41
    v_bfi_b32 v122, v4, v50, v42
    v_bfi_b32 v123, v4, v51, v43
    v_bfi_b32 v124, v4, v52, v44
    v_bfi_b32 v125, v4, v53, v45
    v_bfi_b32 v126, v4, v54, v46
    v_bfi_b32 v127, v4, v55, v47
    buffer_atomic_add_f32 v120, v3, s[28:31], s63 offen offset:0
    buffer_atomic_add_f32 v121, v3, s[28:31], s63 offen offset:256
    buffer_atomic_add_f32 v122, v3, s[28:31], s63 offen offset:512
    buffer_atomic_add_f32 v123, v3, s[28:31], s63 offen offset:768
    buffer_atomic_add_f32 v124, v3, s[28:31], s63 offen offset:1024
    buffer_atomic_add_f32 v125, v3, s[28:31], s63 offen offset:1280
    buffer_atomic_add_f32 v126, v3, s[28:31], s63 offen offset:1536
    buffer_atomic_add_f32 v127, v3, s[28:31], s63 offen offset:1792
    s_mov_b32 exec_hi, 0
    buffer_atomic_add_f32 v56, v3, s[28:31], s63 offen offset:2048
    s_mov_b64 exec, -1
    s_setprio 0
    s_branch L_e1
L_qwave:
    v_mov_b32 v251, 0
    s_barrier
    ds_read_b128 v[72:75], v136 offset:0
    ds_read_b128 v[76:79], v136 offset:4096
    ds_read_b64_tr_b16 v[80:81], v140 offset:0
    ds_read_b64_tr_b16 v[82:83], v140 offset:512
    ds_read_b128 v[88:91], v137 offset:0
    ds_read_b128 v[92:95], v137 offset:4096
    ds_read_b64_tr_b16 v[96:97], v140 offset:2048
    ds_read_b64_tr_b16 v[98:99], v140 offset:2560
    s_mov_b32 s48, 0
    s_waitcnt lgkmcnt(4)
    v_mfma_f32_32x32x16_bf16 v[8:23], v[80:83], v[72:75], 0
    ds_read_b128 v[104:107], v138 offset:0
    ds_read_b128 v[108:111], v138 offset:4096
    v_mfma_f32_32x32x16_bf16 v[24:39], v[80:83], v[76:79], 0
    ds_read_b64_tr_b16 v[112:113], v140 offset:4096
    ds_read_b64_tr_b16 v[114:115], v140 offset:4608
L_cqB_39:
    s_add_u32 s49, s49, 1
    s_and_b32 s50, s49, 3
    s_cmp_eq_u32 s50, 0
    s_cselect_b32 s50, 0xfffe8000, s69
    s_waitcnt lgkmcnt(4)
    v_mfma_f32_32x32x16_bf16 v[8:23], v[96:99], v[88:91], v[8:23]
    ds_read_b128 v[120:123], v139 offset:0
    ds_read_b128 v[124:127], v139 offset:4096
    v_mfma_f32_32x32x16_bf16 v[24:39], v[96:99], v[92:95], v[24:39]
    ds_read_b64_tr_b16 v[128:129], v140 offset:6144
    ds_read_b64_tr_b16 v[130:131], v140 offset:6656
    s_cmp_eq_u32 s22, 2
    s_cbranch_scc0 L_nn2_44
    s_cmp_eq_u32 s48, 1
    s_cbranch_scc0 L_nn1_43
    buffer_load_dword v7, v251, s[40:43], 0 offen sc1
L_nn1_43:
    s_cmp_eq_u32 s48, 6
    s_cbranch_scc0 L_nn2_44
    s_mov_b32 s60, 0
    s_branch L_npc_47
L_np_45:
    buffer_load_dword v7, v251, s[40:43], 0 offen sc1
L_npc_47:
    s_add_u32 s60, s60, 1
    s_cmp_gt_u32 s60, 2000000
    s_cbranch_scc1 L_npx_46
    s_waitcnt vmcnt(0)
    v_readfirstlane_b32 s58, v7
    s_nop 0
    s_cmp_eq_u32 s58, 0
    s_cbranch_scc1 L_np_45
L_npx_46:
    s_waitcnt vmcnt(0)
    v_mov_b32 v250, 155648
    ds_write_b32 v250, v7
L_nn2_44:
    v_add_u32 v136, s50, v136
    v_add_u32 v137, s50, v137
    v_add_u32 v138, s50, v138
    v_add_u32 v139, s50, v139
    v_add_u32 v140, s50, v140
    s_barrier
    s_cmp_lt_u32 s48, 7
    s_cbranch_scc0 L_cxqB_40
    s_waitcnt lgkmcnt(4)
    v_mfma_f32_32x32x16_bf16 v[8:23], v[112:115], v[104:107], v[8:23]
    ds_read_b128 v[72:75], v136 offset:0
    ds_read_b128 v[76:79], v136 offset:4096
    v_mfma_f32_32x32x16_bf16 v[24:39], v[112:115], v[108:111], v[24:39]
    ds_read_b64_tr_b16 v[80:81], v140 offset:0
    ds_read_b64_tr_b16 v[82:83], v140 offset:512
    s_waitcnt lgkmcnt(4)
    v_mfma_f32_32x32x16_bf16 v[8:23], v[128:131], v[120:123], v[8:23]
    ds_read_b128 v[88:91], v137 offset:0
    ds_read_b128 v[92:95], v137 offset:4096
    v_mfma_f32_32x32x16_bf16 v[24:39], v[128:131], v[124:127], v[24:39]
    ds_read_b64_tr_b16 v[96:97], v140 offset:2048
    ds_read_b64_tr_b16 v[98:99], v140 offset:2560
    s_add_u32 s48, s48, 1
    s_waitcnt lgkmcnt(4)
    v_mfma_f32_32x32x16_bf16 v[8:23], v[80:83], v[72:75], v[8:23]
    ds_read_b128 v[104:107], v138 offset:0
    ds_read_b128 v[108:111], v138 offset:4096
    v_mfma_f32_32x32x16_bf16 v[24:39], v[80:83], v[76:79], v[24:39]
    ds_read_b64_tr_b16 v[112:113], v140 offset:4096
    ds_read_b64_tr_b16 v[114:115], v140 offset:4608
    s_branch L_cqB_39
L_cxqB_40:
    s_waitcnt lgkmcnt(4)
    v_mfma_f32_32x32x16_bf16 v[8:23], v[112:115], v[104:107], v[8:23]
    v_mfma_f32_32x32x16_bf16 v[24:39], v[112:115], v[108:111], v[24:39]
    s_waitcnt lgkmcnt(0)
    v_mfma_f32_32x32x16_bf16 v[8:23], v[128:131], v[120:123], v[8:23]
    v_mfma_f32_32x32x16_bf16 v[24:39], v[128:131], v[124:127], v[24:39]
    v_mov_b32 v2, 155648
    ds_read_b32 v3, v2
    s_waitcnt lgkmcnt(0)
    v_readfirstlane_b32 s25, v3
    s_mov_b32 s61, 0x3eb8aa3b
    v_lshlrev_b32 v1, 4, v0
    s_lshl_b32 s63, s27, 12
    s_add_u32 s63, s63, 147456
    v_add_u32 v4, s63, v1
    s_nop 6
    v_mul_f32 v8, s61, v8
    v_mul_f32 v9, s61, v9
    v_mul_f32 v10, s61, v10
    v_mul_f32 v11, s61, v11
    v_mul_f32 v12, s61, v12
    v_mul_f32 v13, s61, v13
    v_mul_f32 v14, s61, v14
    v_mul_f32 v15, s61, v15
    v_mul_f32 v16, s61, v16
    v_mul_f32 v17, s61, v17
    v_mul_f32 v18, s61, v18
    v_mul_f32 v19, s61, v19
    v_mul_f32 v20, s61, v20
    v_mul_f32 v21, s61, v21
    v_mul_f32 v22, s61, v22
    v_mul_f32 v23, s61, v23
    v_cvt_pk_bf16_f32 v144, v8, v9
    v_cvt_pk_bf16_f32 v145, v10, v11
    v_cvt_pk_bf16_f32 v146, v12, v13
    v_cvt_pk_bf16_f32 v147, v14, v15
    v_cvt_pk_bf16_f32 v148, v16, v17
    v_cvt_pk_bf16_f32 v149, v18, v19
    v_cvt_pk_bf16_f32 v150, v20, v21
    v_cvt_pk_bf16_f32 v151, v22, v23
    ds_write_b128 v4, v[144:147] offset:0
    ds_write_b128 v4, v[148:151] offset:2048
    v_mul_f32 v24, s61, v24
    v_mul_f32 v25, s61, v25
    v_mul_f32 v26, s61, v26
    v_mul_f32 v27, s61, v27
    v_mul_f32 v28, s61, v28
    v_mul_f32 v29, s61, v29
    v_mul_f32 v30, s61, v30
    v_mul_f32 v31, s61, v31
    v_mul_f32 v32, s61, v32
    v_mul_f32 v33, s61, v33
    v_mul_f32 v34, s61, v34
    v_mul_f32 v35, s61, v35
    v_mul_f32 v36, s61, v36
    v_mul_f32 v37, s61, v37
    v_mul_f32 v38, s61, v38
    v_mul_f32 v39, s61, v39
    v_cvt_pk_bf16_f32 v152, v24, v25
    v_cvt_pk_bf16_f32 v153, v26, v27
    v_cvt_pk_bf16_f32 v154, v28, v29
    v_cvt_pk_bf16_f32 v155, v30, v31
    v_cvt_pk_bf16_f32 v156, v32, v33
    v_cvt_pk_bf16_f32 v157, v34, v35
    v_cvt_pk_bf16_f32 v158, v36, v37
    v_cvt_pk_bf16_f32 v159, v38, v39
    ds_write_b128 v4, v[152:155] offset:1024
    ds_write_b128 v4, v[156:159] offset:3072
    s_barrier
    ds_read_b128 v[72:75], v136 offset:0
    ds_read_b128 v[76:79], v136 offset:4096
    ds_read_b64_tr_b16 v[80:81], v140 offset:0
    ds_read_b64_tr_b16 v[82:83], v140 offset:512
    ds_read_b128 v[88:91], v137 offset:0
    ds_read_b128 v[92:95], v137 offset:4096
    ds_read_b64_tr_b16 v[96:97], v140 offset:2048
    ds_read_b64_tr_b16 v[98:99], v140 offset:2560
    s_mov_b32 s48, 0
    s_waitcnt lgkmcnt(4)
    v_mfma_f32_32x32x16_bf16 v[8:23], v[80:83], v[72:75], 0
    ds_read_b128 v[104:107], v138 offset:0
    ds_read_b128 v[108:111], v138 offset:4096
    v_mfma_f32_32x32x16_bf16 v[24:39], v[80:83], v[76:79], 0
    ds_read_b64_tr_b16 v[112:113], v140 offset:4096
    ds_read_b64_tr_b16 v[114:115], v140 offset:4608
L_cqA_48:
    s_add_u32 s49, s49, 1
    s_and_b32 s50, s49, 3
    s_cmp_eq_u32 s50, 0
    s_cselect_b32 s50, 0xfffe8000, s69
    s_waitcnt lgkmcnt(4)
    v_mfma_f32_32x32x16_bf16 v[8:23], v[96:99], v[88:91], v[8:23]
    ds_read_b128 v[120:123], v139 offset:0
    ds_read_b128 v[124:127], v139 offset:4096
    v_mfma_f32_32x32x16_bf16 v[24:39], v[96:99], v[92:95], v[24:39]
    ds_read_b64_tr_b16 v[128:129], v140 offset:6144
    ds_read_b64_tr_b16 v[130:131], v140 offset:6656
    v_add_u32 v136, s50, v136
    v_add_u32 v137, s50, v137
    v_add_u32 v138, s50, v138
    v_add_u32 v139, s50, v139
    v_add_u32 v140, s50, v140
    s_barrier
    s_cmp_lt_u32 s48, 7
    s_cbranch_scc0 L_cxqA_49
    s_waitcnt lgkmcnt(4)
    v_mfma_f32_32x32x16_bf16 v[8:23], v[112:115], v[104:107], v[8:23]
    ds_read_b128 v[72:75], v136 offset:0
    ds_read_b128 v[76:79], v136 offset:4096
    v_mfma_f32_32x32x16_bf16 v[24:39], v[112:115], v[108:111], v[24:39]
    ds_read_b64_tr_b16 v[80:81], v140 offset:0
    ds_read_b64_tr_b16 v[82:83], v140 offset:512
    s_waitcnt lgkmcnt(4)
    v_mfma_f32_32x32x16_bf16 v[8:23], v[128:131], v[120:123], v[8:23]
    ds_read_b128 v[88:91], v137 offset:0
    ds_read_b128 v[92:95], v137 offset:4096
    v_mfma_f32_32x32x16_bf16 v[24:39], v[128:131], v[124:127], v[24:39]
    ds_read_b64_tr_b16 v[96:97], v140 offset:2048
    ds_read_b64_tr_b16 v[98:99], v140 offset:2560
    s_add_u32 s48, s48, 1
    s_waitcnt lgkmcnt(4)
    v_mfma_f32_32x32x16_bf16 v[8:23], v[80:83], v[72:75], v[8:23]
    ds_read_b128 v[104:107], v138 offset:0
    ds_read_b128 v[108:111], v138 offset:4096
    v_mfma_f32_32x32x16_bf16 v[24:39], v[80:83], v[76:79], v[24:39]
    ds_read_b64_tr_b16 v[112:113], v140 offset:4096
    ds_read_b64_tr_b16 v[114:115], v140 offset:4608
    s_branch L_cqA_48
L_cxqA_49:
    s_waitcnt lgkmcnt(4)
    v_mfma_f32_32x32x16_bf16 v[8:23], v[112:115], v[104:107], v[8:23]
    v_mfma_f32_32x32x16_bf16 v[24:39], v[112:115], v[108:111], v[24:39]
    s_waitcnt lgkmcnt(0)
    v_mfma_f32_32x32x16_bf16 v[8:23], v[128:131], v[120:123], v[8:23]
    v_mfma_f32_32x32x16_bf16 v[24:39], v[128:131], v[124:127], v[24:39]
    s_waitcnt lgkmcnt(0)
    s_mov_b32 s61, 0x3fb8aa3b
    s_mov_b32 s62, 0x358637bd
    s_mov_b32 s63, s62
    s_mov_b32 s66, s61
    s_mov_b32 s67, s61
    v_lshlrev_b32 v1, 4, v0
    s_lshl_b32 s65, s27, 12
    s_add_u32 s65, s65, 155648
    v_add_u32 v4, s65, v1
    s_nop 6
    v_pk_mul_f32 v[72:73], v[8:9], s[66:67]
    v_pk_mul_f32 v[74:75], v[10:11], s[66:67]
    v_pk_mul_f32 v[76:77], v[12:13], s[66:67]
    v_pk_mul_f32 v[78:79], v[14:15], s[66:67]
    v_exp_f32 v72, v72 clamp
    v_exp_f32 v73, v73 clamp
    v_exp_f32 v74, v74 clamp
    v_exp_f32 v75, v75 clamp
    v_exp_f32 v76, v76 clamp
    v_exp_f32 v77, v77 clamp
    v_exp_f32 v78, v78 clamp
    v_exp_f32 v79, v79 clamp
    v_max_f32 v8, 0, v8
    v_max_f32 v9, 0, v9
    v_max_f32 v10, 0, v10
    v_max_f32 v11, 0, v11
    v_max_f32 v12, 0, v12
    v_max_f32 v13, 0, v13
    v_max_f32 v14, 0, v14
    v_max_f32 v15, 0, v15
    v_pk_add_f32 v[8:9], v[8:9], s[62:63]
    v_pk_add_f32 v[10:11], v[10:11], s[62:63]
    v_pk_add_f32 v[12:13], v[12:13], s[62:63]
    v_pk_add_f32 v[14:15], v[14:15], s[62:63]
    v_pk_add_f32 v[8:9], v[8:9], v[72:73]
    v_pk_add_f32 v[10:11], v[10:11], v[74:75]
    v_pk_add_f32 v[12:13], v[12:13], v[76:77]
    v_pk_add_f32 v[14:15], v[14:15], v[78:79]
    v_pk_mul_f32 v[72:73], v[16:17], s[66:67]
    v_pk_mul_f32 v[74:75], v[18:19], s[66:67]
    v_pk_mul_f32 v[76:77], v[20:21], s[66:67]
    v_pk_mul_f32 v[78:79], v[22:23], s[66:67]
    v_exp_f32 v72, v72 clamp
    v_exp_f32 v73, v73 clamp
    v_exp_f32 v74, v74 clamp
    v_exp_f32 v75, v75 clamp
    v_exp_f32 v76, v76 clamp
    v_exp_f32 v77, v77 clamp
    v_exp_f32 v78, v78 clamp
    v_exp_f32 v79, v79 clamp
    v_max_f32 v16, 0, v16
    v_max_f32 v17, 0, v17
    v_max_f32 v18, 0, v18
    v_max_f32 v19, 0, v19
    v_max_f32 v20, 0, v20
    v_max_f32 v21, 0, v21
    v_max_f32 v22, 0, v22
    v_max_f32 v23, 0, v23
    v_pk_add_f32 v[16:17], v[16:17], s[62:63]
    v_pk_add_f32 v[18:19], v[18:19], s[62:63]
    v_pk_add_f32 v[20:21], v[20:21], s[62:63]
    v_pk_add_f32 v[22:23], v[22:23], s[62:63]
    v_pk_add_f32 v[16:17], v[16:17], v[72:73]
    v_pk_add_f32 v[18:19], v[18:19], v[74:75]
    v_pk_add_f32 v[20:21], v[20:21], v[76:77]
    v_pk_add_f32 v[22:23], v[22:23], v[78:79]
    v_cvt_pk_bf16_f32 v144, v8, v9
    v_cvt_pk_bf16_f32 v145, v10, v11
    v_cvt_pk_bf16_f32 v146, v12, v13
    v_cvt_pk_bf16_f32 v147, v14, v15
    v_cvt_pk_bf16_f32 v148, v16, v17
    v_cvt_pk_bf16_f32 v149, v18, v19
    v_cvt_pk_bf16_f32 v150, v20, v21
    v_cvt_pk_bf16_f32 v151, v22, v23
    ds_write_b128 v4, v[144:147] offset:0
    ds_write_b128 v4, v[148:151] offset:2048
    s_barrier
    v_pk_mul_f32 v[72:73], v[24:25], s[66:67]
    v_pk_mul_f32 v[74:75], v[26:27], s[66:67]
    v_pk_mul_f32 v[76:77], v[28:29], s[66:67]
    v_pk_mul_f32 v[78:79], v[30:31], s[66:67]
    v_exp_f32 v72, v72 clamp
    v_exp_f32 v73, v73 clamp
    v_exp_f32 v74, v74 clamp
    v_exp_f32 v75, v75 clamp
    v_exp_f32 v76, v76 clamp
    v_exp_f32 v77, v77 clamp
    v_exp_f32 v78, v78 clamp
    v_exp_f32 v79, v79 clamp
    v_max_f32 v24, 0, v24
    v_max_f32 v25, 0, v25
    v_max_f32 v26, 0, v26
    v_max_f32 v27, 0, v27
    v_max_f32 v28, 0, v28
    v_max_f32 v29, 0, v29
    v_max_f32 v30, 0, v30
    v_max_f32 v31, 0, v31
    v_pk_add_f32 v[24:25], v[24:25], s[62:63]
    v_pk_add_f32 v[26:27], v[26:27], s[62:63]
    v_pk_add_f32 v[28:29], v[28:29], s[62:63]
    v_pk_add_f32 v[30:31], v[30:31], s[62:63]
    v_pk_add_f32 v[24:25], v[24:25], v[72:73]
    v_pk_add_f32 v[26:27], v[26:27], v[74:75]
    v_pk_add_f32 v[28:29], v[28:29], v[76:77]
    v_pk_add_f32 v[30:31], v[30:31], v[78:79]
    v_pk_mul_f32 v[72:73], v[32:33], s[66:67]
    v_pk_mul_f32 v[74:75], v[34:35], s[66:67]
    v_pk_mul_f32 v[76:77], v[36:37], s[66:67]
    v_pk_mul_f32 v[78:79], v[38:39], s[66:67]
    v_exp_f32 v72, v72 clamp
    v_exp_f32 v73, v73 clamp
    v_exp_f32 v74, v74 clamp
    v_exp_f32 v75, v75 clamp
    v_exp_f32 v76, v76 clamp
    v_exp_f32 v77, v77 clamp
    v_exp_f32 v78, v78 clamp
    v_exp_f32 v79, v79 clamp
    v_max_f32 v32, 0, v32
    v_max_f32 v33, 0, v33
    v_max_f32 v34, 0, v34
    v_max_f32 v35, 0, v35
    v_max_f32 v36, 0, v36
    v_max_f32 v37, 0, v37
    v_max_f32 v38, 0, v38
    v_max_f32 v39, 0, v39
    v_pk_add_f32 v[32:33], v[32:33], s[62:63]
    v_pk_add_f32 v[34:35], v[34:35], s[62:63]
    v_pk_add_f32 v[36:37], v[36:37], s[62:63]
    v_pk_add_f32 v[38:39], v[38:39], s[62:63]
    v_pk_add_f32 v[32:33], v[32:33], v[72:73]
    v_pk_add_f32 v[34:35], v[34:35], v[74:75]
    v_pk_add_f32 v[36:37], v[36:37], v[76:77]
    v_pk_add_f32 v[38:39], v[38:39], v[78:79]
    v_cvt_pk_bf16_f32 v152, v24, v25
    v_cvt_pk_bf16_f32 v153, v26, v27
    v_cvt_pk_bf16_f32 v154, v28, v29
    v_cvt_pk_bf16_f32 v155, v30, v31
    v_cvt_pk_bf16_f32 v156, v32, v33
    v_cvt_pk_bf16_f32 v157, v34, v35
    v_cvt_pk_bf16_f32 v158, v36, v37
    v_cvt_pk_bf16_f32 v159, v38, v39
    ds_write_b128 v4, v[152:155] offset:1024
    ds_write_b128 v4, v[156:159] offset:3072
    s_waitcnt lgkmcnt(0)
L_e1:
L_attn:
    s_and_b32 s26, s22, 1
    s_lshr_b32 s27, s22, 1
    s_lshl_b32 s48, s23, 1
    s_add_u32 s48, s48, s26
    v_lshlrev_b32 v1, 4, v0
    s_lshl_b32 s49, s27, 11
    s_lshl_b32 s50, s26, 10
    s_add_u32 s49, s49, s50
    s_add_u32 s49, s49, 147456
    v_add_u32 v2, s49, v1
    ds_read_b128 v[4:7], v2
    ds_read_b128 v[8:11], v196 offset:0
    ds_read_b128 v[12:15], v196 offset:1024
    ds_read_b128 v[16:19], v196 offset:2048
    ds_read_b128 v[20:23], v196 offset:3072
    ds_read_b128 v[24:27], v196 offset:4096
    ds_read_b128 v[28:31], v196 offset:5120
    ds_read_b128 v[32:35], v196 offset:6144
    ds_read_b128 v[36:39], v197 offset:0
    ds_read_b128 v[40:43], v198 offset:0
    s_mov_b32 s64, 0xffff
    s_mov_b32 s65, 0xffff
    s_mov_b32 s99, 0
    v_mov_b32 v148, 0x3f803f80
    v_mov_b32 v149, 0x3f803f80
    v_mov_b32 v150, 0x3f803f80
    v_mov_b32 v151, 0x3f803f80
    v_mov_b32 v152, 0x3f803f80
    v_mov_b32 v153, 0x3f803f80
    v_mov_b32 v154, 0x3f803f80
    v_mov_b32 v155, 0x3f803f80
    v_mov_b32 v156, 0x3f803f80
    v_mov_b32 v157, 0x3f803f80
    v_mov_b32 v158, 0x3f803f80
    v_mov_b32 v159, 0x3f803f80
    v_mov_b32 v160, 0x3f803f80
    v_mov_b32 v161, 0x3f803f80
    v_mov_b32 v162, 0x3f803f80
    v_mov_b32 v163, 0x3f803f80
    s_sub_i32 s95, 8, s48
    s_max_i32 s95, s95, 0
    s_waitcnt lgkmcnt(0)
    s_cmp_eq_u32 s95, 1
    s_cbranch_scc1 L_e1_1_69
    s_cmp_eq_u32 s95, 2
    s_cbranch_scc1 L_e1_2_70
    s_cmp_eq_u32 s95, 3
    s_cbranch_scc1 L_e1_3_71
    s_cmp_eq_u32 s95, 4
    s_cbranch_scc1 L_e1_4_72
    s_cmp_eq_u32 s95, 5
    s_cbranch_scc1 L_e1_5_73
    s_cmp_eq_u32 s95, 6
    s_cbranch_scc1 L_e1_6_74
    s_cmp_eq_u32 s95, 7
    s_cbranch_scc1 L_e1_7_75
    s_cmp_eq_u32 s95, 8
    s_cbranch_scc1 L_e1_8_76
    v_mfma_f32_32x32x16_bf16 v[44:59], v[8:11], v[4:7], v[232:247]
    v_mfma_f32_32x32x16_bf16 v[60:75], v[12:15], v[4:7], 0
    v_mfma_f32_32x32x16_bf16 v[76:91], v[16:19], v[4:7], 0
    s_nop 9
L_p1_0_50:
    v_max3_f32 v192, v44, v45, v192
    v_max3_f32 v192, v46, v47, v192
    v_max3_f32 v192, v48, v49, v192
    v_max3_f32 v192, v50, v51, v192
    v_max3_f32 v192, v52, v53, v192
    v_max3_f32 v192, v54, v55, v192
    v_max3_f32 v192, v56, v57, v192
    v_max3_f32 v192, v58, v59, v192
    v_mfma_f32_32x32x16_bf16 v[44:59], v[20:23], v[4:7], 0
L_p1_1_51:
    v_max3_f32 v192, v60, v61, v192
    v_max3_f32 v192, v62, v63, v192
    v_max3_f32 v192, v64, v65, v192
    v_max3_f32 v192, v66, v67, v192
    v_max3_f32 v192, v68, v69, v192
    v_max3_f32 v192, v70, v71, v192
    v_max3_f32 v192, v72, v73, v192
    v_max3_f32 v192, v74, v75, v192
    v_mfma_f32_32x32x16_bf16 v[60:75], v[24:27], v[4:7], 0
L_p1_2_52:
    v_max3_f32 v192, v76, v77, v192
    v_max3_f32 v192, v78, v79, v192
    v_max3_f32 v192, v80, v81, v192
    v_max3_f32 v192, v82, v83, v192
    v_max3_f32 v192, v84, v85, v192
    v_max3_f32 v192, v86, v87, v192
    v_max3_f32 v192, v88, v89, v192
    v_max3_f32 v192, v90, v91, v192
    v_mfma_f32_32x32x16_bf16 v[76:91], v[28:31], v[4:7], 0
L_p1_3_53:
    v_max3_f32 v192, v44, v45, v192
    v_max3_f32 v192, v46, v47, v192
    v_max3_f32 v192, v48, v49, v192
    v_max3_f32 v192, v50, v51, v192
    v_max3_f32 v192, v52, v53, v192
    v_max3_f32 v192, v54, v55, v192
    v_max3_f32 v192, v56, v57, v192
    v_max3_f32 v192, v58, v59, v192
    v_mfma_f32_32x32x16_bf16 v[44:59], v[32:35], v[4:7], 0
L_p1_4_54:
    v_max3_f32 v192, v60, v61, v192
    v_max3_f32 v192, v62, v63, v192
    v_max3_f32 v192, v64, v65, v192
    v_max3_f32 v192, v66, v67, v192
    v_max3_f32 v192, v68, v69, v192
    v_max3_f32 v192, v70, v71, v192
    v_max3_f32 v192, v72, v73, v192
    v_max3_f32 v192, v74, v75, v192
    v_mfma_f32_32x32x16_bf16 v[60:75], v[36:39], v[4:7], 0
L_p1_5_55:
    v_max3_f32 v192, v76, v77, v192
    v_max3_f32 v192, v78, v79, v192
    v_max3_f32 v192, v80, v81, v192
    v_max3_f32 v192, v82, v83, v192
    v_max3_f32 v192, v84, v85, v192
    v_max3_f32 v192, v86, v87, v192
    v_max3_f32 v192, v88, v89, v192
    v_max3_f32 v192, v90, v91, v192
    v_mfma_f32_32x32x16_bf16 v[76:91], v[40:43], v[4:7], v[216:231]
L_p1_6_56:
    v_max3_f32 v192, v44, v45, v192
    v_max3_f32 v192, v46, v47, v192
    v_max3_f32 v192, v48, v49, v192
    v_max3_f32 v192, v50, v51, v192
    v_max3_f32 v192, v52, v53, v192
    v_max3_f32 v192, v54, v55, v192
    v_max3_f32 v192, v56, v57, v192
    v_max3_f32 v192, v58, v59, v192
L_p1_7_57:
    v_max3_f32 v192, v60, v61, v192
    v_max3_f32 v192, v62, v63, v192
    v_max3_f32 v192, v64, v65, v192
    v_max3_f32 v192, v66, v67, v192
    v_max3_f32 v192, v68, v69, v192
    v_max3_f32 v192, v70, v71, v192
    v_max3_f32 v192, v72, v73, v192
    v_max3_f32 v192, v74, v75, v192
L_p1_8_58:
    v_max3_f32 v192, v76, v77, v192
    v_max3_f32 v192, v78, v79, v192
    v_max3_f32 v192, v80, v81, v192
    v_max3_f32 v192, v82, v83, v192
    v_max3_f32 v192, v84, v85, v192
    v_max3_f32 v192, v86, v87, v192
    v_max3_f32 v192, v88, v89, v192
    v_max3_f32 v192, v90, v91, v192
    v_mov_b32 v193, v192
    s_nop 1
    v_permlane32_swap_b32 v192, v193
    v_max_f32 v192, v192, v193
    v_sub_f32 v192, 0, v192
    v_mov_b32 v124, v192
    v_mov_b32 v125, v192
    v_mov_b32 v126, v192
    v_mov_b32 v127, v192
    v_mov_b32 v128, v192
    v_mov_b32 v129, v192
    v_mov_b32 v130, v192
    v_mov_b32 v131, v192
    v_mov_b32 v132, v192
    v_mov_b32 v133, v192
    v_mov_b32 v134, v192
    v_mov_b32 v135, v192
    v_mov_b32 v136, v192
    v_mov_b32 v137, v192
    v_mov_b32 v138, v192
    v_mov_b32 v139, v192
    v_add_f32 v216, v216, v192
    v_add_f32 v217, v217, v192
    v_add_f32 v218, v218, v192
    v_add_f32 v219, v219, v192
    v_add_f32 v220, v220, v192
    v_add_f32 v221, v221, v192
    v_add_f32 v222, v222, v192
    v_add_f32 v223, v223, v192
    v_add_f32 v224, v224, v192
    v_add_f32 v225, v225, v192
    v_add_f32 v226, v226, v192
    v_add_f32 v227, v227, v192
    v_add_f32 v228, v228, v192
    v_add_f32 v229, v229, v192
    v_add_f32 v230, v230, v192
    v_add_f32 v231, v231, v192
    s_cmp_ge_u32 s22, 4
    s_cbranch_scc0 L_nowo_86
    s_and_b32 s50, s2, 7
    s_lshr_b32 s51, s2, 3
    s_lshr_b32 s52, s50, 2
    s_lshr_b32 s53, s51, 2
    s_cmp_eq_u32 s52, 0
    s_cselect_b32 s44, s8, s14
    s_cselect_b32 s45, s9, s15
    s_mov_b32 s46, 0x80000
    s_mov_b32 s47, 0x20000
    v_lshrrev_b32 v204, 3, v0
    v_and_b32 v205, 7, v0
    v_and_b32 v206, 2, v204
    v_lshlrev_b32 v206, 1, v206
    v_xor_b32 v206, v205, v206
    v_lshlrev_b32 v206, 4, v206
    s_sub_u32 s54, s22, 4
    s_lshl_b32 s50, s54, 7
    v_add_u32 v204, s50, v204
    v_lshlrev_b32 v204, 10, v204
    s_lshl_b32 s96, s50, 7
    s_lshl_b32 s50, s53, 7
    v_add3_u32 v205, v204, v206, s50
    s_add_u32 s96, s96, 65536
    s_mov_b32 s97, 0
    s_mov_b32 m0, s96
    s_add_u32 s98, s97, 7168
    buffer_load_dwordx4 v205, s[44:47], s97 offen lds
    buffer_load_dwordx4 v205, s[44:47], s98 offen offset:1024 lds
    s_add_u32 s96, s96, 2048
    s_add_u32 s97, s97, 16384
    s_mov_b32 m0, s96
    s_add_u32 s98, s97, 7168
    buffer_load_dwordx4 v205, s[44:47], s97 offen lds
    buffer_load_dwordx4 v205, s[44:47], s98 offen offset:1024 lds
    s_add_u32 s96, s96, 2048
    s_add_u32 s97, s97, 16384
    s_mov_b32 m0, s96
    s_add_u32 s98, s97, 7168
    buffer_load_dwordx4 v205, s[44:47], s97 offen lds
    buffer_load_dwordx4 v205, s[44:47], s98 offen offset:1024 lds
    s_add_u32 s96, s96, 2048
    s_add_u32 s97, s97, 16384
    s_mov_b32 m0, s96
    s_add_u32 s98, s97, 7168
    buffer_load_dwordx4 v205, s[44:47], s97 offen lds
    buffer_load_dwordx4 v205, s[44:47], s98 offen offset:1024 lds
    s_add_u32 s96, s96, 2048
    s_add_u32 s97, s97, 16384
    s_mov_b32 m0, s96
    s_add_u32 s98, s97, 7168
    buffer_load_dwordx4 v205, s[44:47], s97 offen lds
    buffer_load_dwordx4 v205, s[44:47], s98 offen offset:1024 lds
    s_add_u32 s96, s96, 2048
    s_add_u32 s97, s97, 16384
    s_mov_b32 m0, s96
    s_add_u32 s98, s97, 7168
    buffer_load_dwordx4 v205, s[44:47], s97 offen lds
    buffer_load_dwordx4 v205, s[44:47], s98 offen offset:1024 lds
    s_add_u32 s96, s96, 2048
    s_add_u32 s97, s97, 16384
    s_mov_b32 m0, s96
    s_add_u32 s98, s97, 7168
    buffer_load_dwordx4 v205, s[44:47], s97 offen lds
    buffer_load_dwordx4 v205, s[44:47], s98 offen offset:1024 lds
    s_add_u32 s96, s96, 2048
    s_add_u32 s97, s97, 16384
    s_mov_b32 m0, s96
    s_add_u32 s98, s97, 7168
    buffer_load_dwordx4 v205, s[44:47], s97 offen lds
    buffer_load_dwordx4 v205, s[44:47], s98 offen offset:1024 lds
    s_add_u32 s96, s96, 2048
    s_add_u32 s97, s97, 16384
L_nowo_86:
    s_cmp_eq_u32 s95, 0
    s_cbranch_scc0 L_short2_87
    v_add_f32 v232, v232, v192
    v_add_f32 v233, v233, v192
    v_add_f32 v234, v234, v192
    v_add_f32 v235, v235, v192
    v_add_f32 v236, v236, v192
    v_add_f32 v237, v237, v192
    v_add_f32 v238, v238, v192
    v_add_f32 v239, v239, v192
    v_add_f32 v240, v240, v192
    v_add_f32 v241, v241, v192
    v_add_f32 v242, v242, v192
    v_add_f32 v243, v243, v192
    v_add_f32 v244, v244, v192
    v_add_f32 v245, v245, v192
    v_add_f32 v246, v246, v192
    v_add_f32 v247, v247, v192
    s_mov_b64 exec, s[64:65]
    ds_read_b128 v[148:151], v199 offset:0
    ds_read_b128 v[152:155], v199 offset:512
    s_mov_b64 exec, -1
    s_nop 0
    v_mfma_f32_32x32x16_bf16 v[44:59], v[8:11], v[4:7], v[232:247]
    s_nop 6
L_p2_0_59:
    v_mfma_f32_32x32x16_bf16 v[60:75], v[12:15], v[4:7], v[124:139]
    s_mov_b64 exec, s[64:65]
    ds_read_b128 v[156:159], v199 offset:1024
    ds_read_b128 v[160:163], v199 offset:1536
    s_mov_b64 exec, -1
    v_exp_f32 v44, v44
    v_exp_f32 v45, v45
    v_exp_f32 v46, v46
    v_exp_f32 v47, v47
    v_exp_f32 v48, v48
    v_exp_f32 v49, v49
    v_exp_f32 v50, v50
    v_exp_f32 v51, v51
    v_exp_f32 v52, v52
    v_exp_f32 v53, v53
    v_exp_f32 v54, v54
    v_exp_f32 v55, v55
    v_exp_f32 v56, v56
    v_exp_f32 v57, v57
    v_exp_f32 v58, v58
    v_exp_f32 v59, v59
    v_cvt_pk_bf16_f32 v140, v44, v45
    v_cvt_pk_bf16_f32 v141, v46, v47
    v_cvt_pk_bf16_f32 v142, v48, v49
    v_cvt_pk_bf16_f32 v143, v50, v51
    v_cvt_pk_bf16_f32 v144, v52, v53
    v_cvt_pk_bf16_f32 v145, v54, v55
    v_cvt_pk_bf16_f32 v146, v56, v57
    v_cvt_pk_bf16_f32 v147, v58, v59
    s_waitcnt lgkmcnt(2)
    v_mfma_f32_32x32x16_bf16 v[176:191], v[148:151], v[140:143], 0
    s_nop 0
    v_mfma_f32_32x32x16_bf16 v[176:191], v[152:155], v[144:147], v[176:191]
L_p2_1_60:
    v_mfma_f32_32x32x16_bf16 v[44:59], v[16:19], v[4:7], v[124:139]
    s_mov_b64 exec, s[64:65]
    ds_read_b128 v[148:151], v199 offset:2048
    ds_read_b128 v[152:155], v199 offset:2560
    s_mov_b64 exec, -1
    v_exp_f32 v60, v60
    v_exp_f32 v61, v61
    v_exp_f32 v62, v62
    v_exp_f32 v63, v63
    v_exp_f32 v64, v64
    v_exp_f32 v65, v65
    v_exp_f32 v66, v66
    v_exp_f32 v67, v67
    v_exp_f32 v68, v68
    v_exp_f32 v69, v69
    v_exp_f32 v70, v70
    v_exp_f32 v71, v71
    v_exp_f32 v72, v72
    v_exp_f32 v73, v73
    v_exp_f32 v74, v74
    v_exp_f32 v75, v75
    v_cvt_pk_bf16_f32 v140, v60, v61
    v_cvt_pk_bf16_f32 v141, v62, v63
    v_cvt_pk_bf16_f32 v142, v64, v65
    v_cvt_pk_bf16_f32 v143, v66, v67
    v_cvt_pk_bf16_f32 v144, v68, v69
    v_cvt_pk_bf16_f32 v145, v70, v71
    v_cvt_pk_bf16_f32 v146, v72, v73
    v_cvt_pk_bf16_f32 v147, v74, v75
    s_waitcnt lgkmcnt(2)
    v_mfma_f32_32x32x16_bf16 v[176:191], v[156:159], v[140:143], v[176:191]
    s_nop 0
    v_mfma_f32_32x32x16_bf16 v[176:191], v[160:163], v[144:147], v[176:191]
L_p2_2_61:
    v_mfma_f32_32x32x16_bf16 v[60:75], v[20:23], v[4:7], v[124:139]
    s_mov_b64 exec, s[64:65]
    ds_read_b128 v[156:159], v199 offset:3072
    ds_read_b128 v[160:163], v199 offset:3584
    s_mov_b64 exec, -1
    v_exp_f32 v44, v44
    v_exp_f32 v45, v45
    v_exp_f32 v46, v46
    v_exp_f32 v47, v47
    v_exp_f32 v48, v48
    v_exp_f32 v49, v49
    v_exp_f32 v50, v50
    v_exp_f32 v51, v51
    v_exp_f32 v52, v52
    v_exp_f32 v53, v53
    v_exp_f32 v54, v54
    v_exp_f32 v55, v55
    v_exp_f32 v56, v56
    v_exp_f32 v57, v57
    v_exp_f32 v58, v58
    v_exp_f32 v59, v59
    v_cvt_pk_bf16_f32 v140, v44, v45
    v_cvt_pk_bf16_f32 v141, v46, v47
    v_cvt_pk_bf16_f32 v142, v48, v49
    v_cvt_pk_bf16_f32 v143, v50, v51
    v_cvt_pk_bf16_f32 v144, v52, v53
    v_cvt_pk_bf16_f32 v145, v54, v55
    v_cvt_pk_bf16_f32 v146, v56, v57
    v_cvt_pk_bf16_f32 v147, v58, v59
    s_waitcnt lgkmcnt(2)
    v_mfma_f32_32x32x16_bf16 v[176:191], v[148:151], v[140:143], v[176:191]
    s_nop 0
    v_mfma_f32_32x32x16_bf16 v[176:191], v[152:155], v[144:147], v[176:191]
L_p2_3_62:
    v_mfma_f32_32x32x16_bf16 v[44:59], v[24:27], v[4:7], v[124:139]
    s_mov_b64 exec, s[64:65]
    ds_read_b128 v[148:151], v199 offset:4096
    ds_read_b128 v[152:155], v199 offset:4608
    s_mov_b64 exec, -1
    s_cmp_eq_u32 s95, 0
    s_cbranch_scc0 L_nohook_93
    s_cmp_lt_u32 s22, 2
    s_cbranch_scc0 L_nosigA_94
    s_waitcnt vmcnt(0)
    s_lshl_b32 s52, s24, 13
    s_lshl_b32 s53, s23, 1
    s_add_u32 s53, s53, s22
    s_lshl_b32 s53, s53, 7
    s_add_u32 s52, s52, s53
    s_add_u32 s52, s52, 8486912
    v_mov_b32 v250, s25
    v_mov_b32 v251, 0
    s_mov_b64 exec, 1
    buffer_store_dword v250, v251, s[28:31], s52 offen sc1
    s_mov_b64 exec, -1
L_nosigA_94:
L_nohook_93:
    v_exp_f32 v60, v60
    v_exp_f32 v61, v61
    v_exp_f32 v62, v62
    v_exp_f32 v63, v63
    v_exp_f32 v64, v64
    v_exp_f32 v65, v65
    v_exp_f32 v66, v66
    v_exp_f32 v67, v67
    v_exp_f32 v68, v68
    v_exp_f32 v69, v69
    v_exp_f32 v70, v70
    v_exp_f32 v71, v71
    v_exp_f32 v72, v72
    v_exp_f32 v73, v73
    v_exp_f32 v74, v74
    v_exp_f32 v75, v75
    v_cvt_pk_bf16_f32 v140, v60, v61
    v_cvt_pk_bf16_f32 v141, v62, v63
    v_cvt_pk_bf16_f32 v142, v64, v65
    v_cvt_pk_bf16_f32 v143, v66, v67
    v_cvt_pk_bf16_f32 v144, v68, v69
    v_cvt_pk_bf16_f32 v145, v70, v71
    v_cvt_pk_bf16_f32 v146, v72, v73
    v_cvt_pk_bf16_f32 v147, v74, v75
    s_waitcnt lgkmcnt(2)
    v_mfma_f32_32x32x16_bf16 v[176:191], v[156:159], v[140:143], v[176:191]
    s_nop 0
    v_mfma_f32_32x32x16_bf16 v[176:191], v[160:163], v[144:147], v[176:191]
L_p2_4_63:
    v_mfma_f32_32x32x16_bf16 v[60:75], v[28:31], v[4:7], v[124:139]
    s_mov_b64 exec, s[64:65]
    ds_read_b128 v[156:159], v199 offset:5120
    ds_read_b128 v[160:163], v199 offset:5632
    s_mov_b64 exec, -1
    s_cmp_eq_u32 s22, 4
    s_cbranch_scc0 L_hk_96
    s_cmp_eq_u32 s95, 0
    s_cbranch_scc0 L_hk_96
    s_cmp_eq_u32 s99, 0
    s_cbranch_scc0 L_hk_96
    buffer_load_dword v248, v249, s[28:31], 0 offen sc1
L_hk_96:
    v_exp_f32 v44, v44
    v_exp_f32 v45, v45
    v_exp_f32 v46, v46
    v_exp_f32 v47, v47
    v_exp_f32 v48, v48
    v_exp_f32 v49, v49
    v_exp_f32 v50, v50
    v_exp_f32 v51, v51
    v_exp_f32 v52, v52
    v_exp_f32 v53, v53
    v_exp_f32 v54, v54
    v_exp_f32 v55, v55
    v_exp_f32 v56, v56
    v_exp_f32 v57, v57
    v_exp_f32 v58, v58
    v_exp_f32 v59, v59
    v_cvt_pk_bf16_f32 v140, v44, v45
    v_cvt_pk_bf16_f32 v141, v46, v47
    v_cvt_pk_bf16_f32 v142, v48, v49
    v_cvt_pk_bf16_f32 v143, v50, v51
    v_cvt_pk_bf16_f32 v144, v52, v53
    v_cvt_pk_bf16_f32 v145, v54, v55
    v_cvt_pk_bf16_f32 v146, v56, v57
    v_cvt_pk_bf16_f32 v147, v58, v59
    s_waitcnt lgkmcnt(2)
    v_mfma_f32_32x32x16_bf16 v[176:191], v[148:151], v[140:143], v[176:191]
    s_nop 0
    v_mfma_f32_32x32x16_bf16 v[176:191], v[152:155], v[144:147], v[176:191]
L_p2_5_64:
    v_mfma_f32_32x32x16_bf16 v[44:59], v[32:35], v[4:7], v[124:139]
    s_mov_b64 exec, s[64:65]
    ds_read_b128 v[148:151], v199 offset:6144
    ds_read_b128 v[152:155], v199 offset:6656
    s_mov_b64 exec, -1
    s_cmp_eq_u32 s22, 4
    s_cbranch_scc0 L_hk_98
    s_cmp_eq_u32 s95, 0
    s_cbranch_scc0 L_hk_98
    s_cmp_eq_u32 s99, 0
    s_cbranch_scc0 L_hk_98
    buffer_load_dword v253, v249, s[28:31], 0 offen sc1
L_hk_98:
    v_exp_f32 v60, v60
    v_exp_f32 v61, v61
    v_exp_f32 v62, v62
    v_exp_f32 v63, v63
    v_exp_f32 v64, v64
    v_exp_f32 v65, v65
    v_exp_f32 v66, v66
    v_exp_f32 v67, v67
    v_exp_f32 v68, v68
    v_exp_f32 v69, v69
    v_exp_f32 v70, v70
    v_exp_f32 v71, v71
    v_exp_f32 v72, v72
    v_exp_f32 v73, v73
    v_exp_f32 v74, v74
    v_exp_f32 v75, v75
    v_cvt_pk_bf16_f32 v140, v60, v61
    v_cvt_pk_bf16_f32 v141, v62, v63
    v_cvt_pk_bf16_f32 v142, v64, v65
    v_cvt_pk_bf16_f32 v143, v66, v67
    v_cvt_pk_bf16_f32 v144, v68, v69
    v_cvt_pk_bf16_f32 v145, v70, v71
    v_cvt_pk_bf16_f32 v146, v72, v73
    v_cvt_pk_bf16_f32 v147, v74, v75
    s_waitcnt lgkmcnt(2)
    v_mfma_f32_32x32x16_bf16 v[176:191], v[156:159], v[140:143], v[176:191]
    s_nop 0
    v_mfma_f32_32x32x16_bf16 v[176:191], v[160:163], v[144:147], v[176:191]
L_p2_6_65:
    v_mfma_f32_32x32x16_bf16 v[60:75], v[36:39], v[4:7], v[124:139]
    s_mov_b64 exec, s[64:65]
    ds_read_b128 v[156:159], v200 offset:0
    ds_read_b128 v[160:163], v200 offset:512
    s_mov_b64 exec, -1
    s_cmp_eq_u32 s22, 4
    s_cbranch_scc0 L_hk_100
    s_cmp_eq_u32 s95, 0
    s_cbranch_scc0 L_hk_100
    s_cmp_eq_u32 s99, 0
    s_cbranch_scc0 L_hk_100
    s_waitcnt vmcnt(1)
    v_cmp_ne_u32 vcc, s25, v248
    s_nop 1
    s_cbranch_vccz L_got_101
    buffer_load_dword v248, v249, s[28:31], 0 offen sc1
    s_branch L_hk_100
L_got_101:
    s_lshl_b32 s50, s24, 13
    s_add_u32 s50, s50, 8388608
    s_add_u32 s51, s50, 4096
    buffer_load_dwordx4 v[208:211], v1, s[28:31], s50 offen sc1
    buffer_load_dwordx4 v[212:215], v1, s[28:31], s50 offen offset:1024 sc1
    buffer_load_dwordx4 v[164:167], v1, s[28:31], s51 offen sc1
    buffer_load_dwordx4 v[168:171], v1, s[28:31], s51 offen offset:1024 sc1
    v_lshrrev_b32 v202, 5, v0
    v_lshlrev_b32 v202, 12, v202
    v_and_b32 v203, 31, v0
    v_lshl_add_u32 v202, v203, 2, v202
    buffer_load_dword v172, v202, s[28:31], s50 offen offset:2048 sc1
    s_mov_b32 s99, 1
L_hk_100:
    v_exp_f32 v44, v44
    v_exp_f32 v45, v45
    v_exp_f32 v46, v46
    v_exp_f32 v47, v47
    v_exp_f32 v48, v48
    v_exp_f32 v49, v49
    v_exp_f32 v50, v50
    v_exp_f32 v51, v51
    v_exp_f32 v52, v52
    v_exp_f32 v53, v53
    v_exp_f32 v54, v54
    v_exp_f32 v55, v55
    v_exp_f32 v56, v56
    v_exp_f32 v57, v57
    v_exp_f32 v58, v58
    v_exp_f32 v59, v59
    v_cvt_pk_bf16_f32 v140, v44, v45
    v_cvt_pk_bf16_f32 v141, v46, v47
    v_cvt_pk_bf16_f32 v142, v48, v49
    v_cvt_pk_bf16_f32 v143, v50, v51
    v_cvt_pk_bf16_f32 v144, v52, v53
    v_cvt_pk_bf16_f32 v145, v54, v55
    v_cvt_pk_bf16_f32 v146, v56, v57
    v_cvt_pk_bf16_f32 v147, v58, v59
    s_waitcnt lgkmcnt(2)
    v_mfma_f32_32x32x16_bf16 v[176:191], v[148:151], v[140:143], v[176:191]
    s_nop 0
    v_mfma_f32_32x32x16_bf16 v[176:191], v[152:155], v[144:147], v[176:191]
L_p2_7_66:
    v_mfma_f32_32x32x16_bf16 v[44:59], v[40:43], v[4:7], v[216:231]
    s_mov_b64 exec, s[64:65]
    ds_read_b128 v[148:151], v201 offset:0
    ds_read_b128 v[152:155], v201 offset:512
    s_mov_b64 exec, -1
    s_cmp_eq_u32 s22, 4
    s_cbranch_scc0 L_hk_103
    s_cmp_eq_u32 s95, 0
    s_cbranch_scc0 L_hk_103
    s_cmp_eq_u32 s99, 0
    s_cbranch_scc0 L_hk_103
    s_waitcnt vmcnt(1)
    v_cmp_ne_u32 vcc, s25, v253
    s_nop 1
    s_cbranch_vccz L_got_104
    buffer_load_dword v253, v249, s[28:31], 0 offen sc1
    s_branch L_hk_103
L_got_104:
    s_lshl_b32 s50, s24, 13
    s_add_u32 s50, s50, 8388608
    s_add_u32 s51, s50, 4096
    buffer_load_dwordx4 v[208:211], v1, s[28:31], s50 offen sc1
    buffer_load_dwordx4 v[212:215], v1, s[28:31], s50 offen offset:1024 sc1
    buffer_load_dwordx4 v[164:167], v1, s[28:31], s51 offen sc1
    buffer_load_dwordx4 v[168:171], v1, s[28:31], s51 offen offset:1024 sc1
    v_lshrrev_b32 v202, 5, v0
    v_lshlrev_b32 v202, 12, v202
    v_and_b32 v203, 31, v0
    v_lshl_add_u32 v202, v203, 2, v202
    buffer_load_dword v172, v202, s[28:31], s50 offen offset:2048 sc1
    s_mov_b32 s99, 1
L_hk_103:
    v_exp_f32 v60, v60
    v_exp_f32 v61, v61
    v_exp_f32 v62, v62
    v_exp_f32 v63, v63
    v_exp_f32 v64, v64
    v_exp_f32 v65, v65
    v_exp_f32 v66, v66
    v_exp_f32 v67, v67
    v_exp_f32 v68, v68
    v_exp_f32 v69, v69
    v_exp_f32 v70, v70
    v_exp_f32 v71, v71
    v_exp_f32 v72, v72
    v_exp_f32 v73, v73
    v_exp_f32 v74, v74
    v_exp_f32 v75, v75
    v_cvt_pk_bf16_f32 v140, v60, v61
    v_cvt_pk_bf16_f32 v141, v62, v63
    v_cvt_pk_bf16_f32 v142, v64, v65
    v_cvt_pk_bf16_f32 v143, v66, v67
    v_cvt_pk_bf16_f32 v144, v68, v69
    v_cvt_pk_bf16_f32 v145, v70, v71
    v_cvt_pk_bf16_f32 v146, v72, v73
    v_cvt_pk_bf16_f32 v147, v74, v75
    s_waitcnt lgkmcnt(2)
    v_mfma_f32_32x32x16_bf16 v[176:191], v[156:159], v[140:143], v[176:191]
    s_nop 0
    v_mfma_f32_32x32x16_bf16 v[176:191], v[160:163], v[144:147], v[176:191]
L_p2_8_67:
    s_cmp_eq_u32 s22, 4
    s_cbranch_scc0 L_hk_106
    s_cmp_eq_u32 s95, 0
    s_cbranch_scc0 L_hk_106
    s_cmp_eq_u32 s99, 0
    s_cbranch_scc0 L_hk_106
    s_waitcnt vmcnt(1)
    v_cmp_ne_u32 vcc, s25, v248
    s_nop 1
    s_cbranch_vccz L_got_107
    buffer_load_dword v248, v249, s[28:31], 0 offen sc1
    s_branch L_hk_106
L_got_107:
    s_lshl_b32 s50, s24, 13
    s_add_u32 s50, s50, 8388608
    s_add_u32 s51, s50, 4096
    buffer_load_dwordx4 v[208:211], v1, s[28:31], s50 offen sc1
    buffer_load_dwordx4 v[212:215], v1, s[28:31], s50 offen offset:1024 sc1
    buffer_load_dwordx4 v[164:167], v1, s[28:31], s51 offen sc1
    buffer_load_dwordx4 v[168:171], v1, s[28:31], s51 offen offset:1024 sc1
    v_lshrrev_b32 v202, 5, v0
    v_lshlrev_b32 v202, 12, v202
    v_and_b32 v203, 31, v0
    v_lshl_add_u32 v202, v203, 2, v202
    buffer_load_dword v172, v202, s[28:31], s50 offen offset:2048 sc1
    s_mov_b32 s99, 1
L_hk_106:
    v_exp_f32 v44, v44
    v_exp_f32 v45, v45
    v_exp_f32 v46, v46
    v_exp_f32 v47, v47
    v_exp_f32 v48, v48
    v_exp_f32 v49, v49
    v_exp_f32 v50, v50
    v_exp_f32 v51, v51
    v_exp_f32 v52, v52
    v_exp_f32 v53, v53
    v_exp_f32 v54, v54
    v_exp_f32 v55, v55
    v_exp_f32 v56, v56
    v_exp_f32 v57, v57
    v_exp_f32 v58, v58
    v_exp_f32 v59, v59
    v_cvt_pk_bf16_f32 v140, v44, v45
    v_cvt_pk_bf16_f32 v141, v46, v47
    v_cvt_pk_bf16_f32 v142, v48, v49
    v_cvt_pk_bf16_f32 v143, v50, v51
    v_cvt_pk_bf16_f32 v144, v52, v53
    v_cvt_pk_bf16_f32 v145, v54, v55
    v_cvt_pk_bf16_f32 v146, v56, v57
    v_cvt_pk_bf16_f32 v147, v58, v59
    s_waitcnt lgkmcnt(0)
    v_mfma_f32_32x32x16_bf16 v[176:191], v[148:151], v[140:143], v[176:191]
    s_nop 0
    v_mfma_f32_32x32x16_bf16 v[176:191], v[152:155], v[144:147], v[176:191]
    s_branch L_attdone_108
L_e1_1_69:
    v_mfma_f32_32x32x16_bf16 v[60:75], v[12:15], v[4:7], 0
    v_mfma_f32_32x32x16_bf16 v[76:91], v[16:19], v[4:7], 0
    v_mfma_f32_32x32x16_bf16 v[44:59], v[20:23], v[4:7], 0
    s_nop 10
    s_branch L_p1_1_51
L_e1_2_70:
    v_mfma_f32_32x32x16_bf16 v[76:91], v[16:19], v[4:7], 0
    v_mfma_f32_32x32x16_bf16 v[44:59], v[20:23], v[4:7], 0
    v_mfma_f32_32x32x16_bf16 v[60:75], v[24:27], v[4:7], 0
    s_nop 10
    s_branch L_p1_2_52
L_e1_3_71:
    v_mfma_f32_32x32x16_bf16 v[44:59], v[20:23], v[4:7], 0
    v_mfma_f32_32x32x16_bf16 v[60:75], v[24:27], v[4:7], 0
    v_mfma_f32_32x32x16_bf16 v[76:91], v[28:31], v[4:7], 0
    s_nop 10
    s_branch L_p1_3_53
L_e1_4_72:
    v_mfma_f32_32x32x16_bf16 v[60:75], v[24:27], v[4:7], 0
    v_mfma_f32_32x32x16_bf16 v[76:91], v[28:31], v[4:7], 0
    v_mfma_f32_32x32x16_bf16 v[44:59], v[32:35], v[4:7], 0
    s_nop 10
    s_branch L_p1_4_54
L_e1_5_73:
    v_mfma_f32_32x32x16_bf16 v[76:91], v[28:31], v[4:7], 0
    v_mfma_f32_32x32x16_bf16 v[44:59], v[32:35], v[4:7], 0
    v_mfma_f32_32x32x16_bf16 v[60:75], v[36:39], v[4:7], 0
    s_nop 10
    s_branch L_p1_5_55
L_e1_6_74:
    v_mfma_f32_32x32x16_bf16 v[44:59], v[32:35], v[4:7], 0
    v_mfma_f32_32x32x16_bf16 v[60:75], v[36:39], v[4:7], 0
    v_mfma_f32_32x32x16_bf16 v[76:91], v[40:43], v[4:7], v[216:231]
    s_nop 10
    s_branch L_p1_6_56
L_e1_7_75:
    v_mfma_f32_32x32x16_bf16 v[60:75], v[36:39], v[4:7], 0
    v_mfma_f32_32x32x16_bf16 v[76:91], v[40:43], v[4:7], v[216:231]
    s_nop 10
    s_branch L_p1_7_57
L_e1_8_76:
    v_mfma_f32_32x32x16_bf16 v[76:91], v[40:43], v[4:7], v[216:231]
    s_nop 10
    s_branch L_p1_8_58
L_short2_87:
    v_mov_b32 v176, 0
    v_mov_b32 v177, 0
    v_mov_b32 v178, 0
    v_mov_b32 v179, 0
    v_mov_b32 v180, 0
    v_mov_b32 v181, 0
    v_mov_b32 v182, 0
    v_mov_b32 v183, 0
    v_mov_b32 v184, 0
    v_mov_b32 v185, 0
    v_mov_b32 v186, 0
    v_mov_b32 v187, 0
    v_mov_b32 v188, 0
    v_mov_b32 v189, 0
    v_mov_b32 v190, 0
    v_mov_b32 v191, 0
    s_cmp_lt_u32 s22, 2
    s_cbranch_scc0 L_nosigA_109
    s_waitcnt vmcnt(0)
    s_lshl_b32 s52, s24, 13
    s_lshl_b32 s53, s23, 1
    s_add_u32 s53, s53, s22
    s_lshl_b32 s53, s53, 7
    s_add_u32 s52, s52, s53
    s_add_u32 s52, s52, 8486912
    v_mov_b32 v250, s25
    v_mov_b32 v251, 0
    s_mov_b64 exec, 1
    buffer_store_dword v250, v251, s[28:31], s52 offen sc1
    s_mov_b64 exec, -1
L_nosigA_109:
    s_cmp_eq_u32 s22, 4
    s_cbranch_scc0 L_shpoll_110
    buffer_load_dword v248, v249, s[28:31], 0 offen sc1
L_shpoll_110:
    s_cmp_eq_u32 s95, 1
    s_cbranch_scc1 L_e2_1_78
    s_cmp_eq_u32 s95, 2
    s_cbranch_scc1 L_e2_2_79
    s_cmp_eq_u32 s95, 3
    s_cbranch_scc1 L_e2_3_80
    s_cmp_eq_u32 s95, 4
    s_cbranch_scc1 L_e2_4_81
    s_cmp_eq_u32 s95, 5
    s_cbranch_scc1 L_e2_5_82
    s_cmp_eq_u32 s95, 6
    s_cbranch_scc1 L_e2_6_83
    s_cmp_eq_u32 s95, 7
    s_cbranch_scc1 L_e2_7_84
    s_cmp_eq_u32 s95, 8
    s_cbranch_scc1 L_e2_8_85
    s_branch L_e2_8_85
L_e2_1_78:
    v_mfma_f32_32x32x16_bf16 v[60:75], v[12:15], v[4:7], v[124:139]
    s_mov_b64 exec, s[64:65]
    ds_read_b128 v[156:159], v199 offset:1024
    ds_read_b128 v[160:163], v199 offset:1536
    s_mov_b64 exec, -1
    s_nop 6
    s_branch L_p2_1_60
L_e2_2_79:
    v_mfma_f32_32x32x16_bf16 v[44:59], v[16:19], v[4:7], v[124:139]
    s_mov_b64 exec, s[64:65]
    ds_read_b128 v[148:151], v199 offset:2048
    ds_read_b128 v[152:155], v199 offset:2560
    s_mov_b64 exec, -1
    s_nop 6
    s_branch L_p2_2_61
L_e2_3_80:
    v_mfma_f32_32x32x16_bf16 v[60:75], v[20:23], v[4:7], v[124:139]
    s_mov_b64 exec, s[64:65]
    ds_read_b128 v[156:159], v199 offset:3072
    ds_read_b128 v[160:163], v199 offset:3584
    s_mov_b64 exec, -1
    s_nop 6
    s_branch L_p2_3_62
L_e2_4_81:
    v_mfma_f32_32x32x16_bf16 v[44:59], v[24:27], v[4:7], v[124:139]
    s_mov_b64 exec, s[64:65]
    ds_read_b128 v[148:151], v199 offset:4096
    ds_read_b128 v[152:155], v199 offset:4608
    s_mov_b64 exec, -1
    s_nop 6
    s_branch L_p2_4_63
L_e2_5_82:
    v_mfma_f32_32x32x16_bf16 v[60:75], v[28:31], v[4:7], v[124:139]
    s_mov_b64 exec, s[64:65]
    ds_read_b128 v[156:159], v199 offset:5120
    ds_read_b128 v[160:163], v199 offset:5632
    s_mov_b64 exec, -1
    s_nop 6
    s_branch L_p2_5_64
L_e2_6_83:
    v_mfma_f32_32x32x16_bf16 v[44:59], v[32:35], v[4:7], v[124:139]
    s_mov_b64 exec, s[64:65]
    ds_read_b128 v[148:151], v199 offset:6144
    ds_read_b128 v[152:155], v199 offset:6656
    s_mov_b64 exec, -1
    s_nop 6
    s_branch L_p2_6_65
L_e2_7_84:
    v_mfma_f32_32x32x16_bf16 v[60:75], v[36:39], v[4:7], v[124:139]
    s_mov_b64 exec, s[64:65]
    ds_read_b128 v[156:159], v200 offset:0
    ds_read_b128 v[160:163], v200 offset:512
    s_mov_b64 exec, -1
    s_nop 6
    s_branch L_p2_7_66
L_e2_8_85:
    v_mfma_f32_32x32x16_bf16 v[44:59], v[40:43], v[4:7], v[216:231]
    s_mov_b64 exec, s[64:65]
    ds_read_b128 v[148:151], v201 offset:0
    ds_read_b128 v[152:155], v201 offset:512
    s_mov_b64 exec, -1
    s_nop 6
    s_branch L_p2_8_67
L_attdone_108:
    s_cmp_eq_u32 s22, 4
    s_cbranch_scc0 L_kvdone_111
    s_cmp_eq_u32 s99, 1
    s_cbranch_scc1 L_kvdone_111
    s_mov_b32 s60, 0
L_f1a_poll_112:
    buffer_load_dword v248, v249, s[28:31], 0 offen sc1
L_f1a_chk_114:
    s_add_u32 s60, s60, 1
    s_cmp_gt_u32 s60, 2000000
    s_cbranch_scc1 L_f1a_done_113
    s_waitcnt vmcnt(0)
    v_cmp_ne_u32 vcc, s25, v248
    s_nop 1
    s_cbranch_vccz L_f1a_done_113
    s_sleep 1
    s_branch L_f1a_poll_112
L_f1a_done_113:
    s_waitcnt vmcnt(0)
    s_lshl_b32 s50, s24, 13
    s_add_u32 s50, s50, 8388608
    s_add_u32 s51, s50, 4096
    buffer_load_dwordx4 v[208:211], v1, s[28:31], s50 offen sc1
    buffer_load_dwordx4 v[212:215], v1, s[28:31], s50 offen offset:1024 sc1
    buffer_load_dwordx4 v[164:167], v1, s[28:31], s51 offen sc1
    buffer_load_dwordx4 v[168:171], v1, s[28:31], s51 offen offset:1024 sc1
    v_lshrrev_b32 v202, 5, v0
    v_lshlrev_b32 v202, 12, v202
    v_and_b32 v203, 31, v0
    v_lshl_add_u32 v202, v203, 2, v202
    buffer_load_dword v172, v202, s[28:31], s50 offen offset:2048 sc1
L_kvdone_111:
    s_nop 8
    v_rcp_f32 v193, v184
    s_nop 0
    v_mul_f32 v176, v176, v193
    v_mul_f32 v177, v177, v193
    v_mul_f32 v178, v178, v193
    v_mul_f32 v179, v179, v193
    v_mul_f32 v180, v180, v193
    v_mul_f32 v181, v181, v193
    v_mul_f32 v182, v182, v193
    v_mul_f32 v183, v183, v193
    v_cvt_pk_bf16_f32 v140, v176, v177
    v_cvt_pk_bf16_f32 v141, v178, v179
    v_cvt_pk_bf16_f32 v142, v180, v181
    v_cvt_pk_bf16_f32 v143, v182, v183
    s_lshl_b32 s49, s24, 2
    s_add_u32 s49, s49, s27
    s_lshl_b32 s50, s48, 5
    s_add_u32 s49, s49, s50
    s_lshl_b32 s49, s49, 10
    s_add_u32 s50, s49, 6291456
    buffer_store_dwordx4 v[140:143], v1, s[28:31], s50 offen sc1
    s_barrier
    s_cmp_eq_u32 s22, 4
    s_cbranch_scc0 L_nokvw_115
    s_waitcnt vmcnt(1)
    ds_write_b128 v1, v[208:211] offset:0
    ds_write_b128 v1, v[212:215] offset:1024
    ds_write_b128 v1, v[164:167] offset:4096
    ds_write_b128 v1, v[168:171] offset:5120
    v_lshrrev_b32 v202, 5, v0
    v_lshlrev_b32 v202, 12, v202
    v_and_b32 v203, 31, v0
    v_lshl_add_u32 v202, v203, 2, v202
    ds_write_b32 v202, v172 offset:2048
    s_waitcnt lgkmcnt(0)
L_nokvw_115:
    s_lshr_b32 s51, s27, 1
    s_lshl_b32 s51, s51, 12
    s_and_b32 s52, s27, 1
    s_lshl_b32 s52, s52, 6
    s_add_u32 s51, s51, s52
    v_lshrrev_b32 v203, 5, v0
    v_and_b32 v202, 15, v0
    v_lshl_add_u32 v202, v203, 5, v202
    v_lshlrev_b32 v202, 2, v202
    v_add_u32 v202, s51, v202
    v_lshlrev_b32 v203, 4, v203
    v_add_u32 v203, s51, v203
    s_lshl_b32 s51, s27, 11
    s_lshl_b32 s50, s26, 10
    s_add_u32 s51, s51, s50
    s_add_u32 s51, s51, 155648
    v_add_u32 v2, s51, v1
    ds_read_b128 v[4:7], v2
    s_barrier
    s_mov_b64 exec, s[64:65]
    ds_read_b32 v208, v202 offset:0
    ds_read_b32 v209, v202 offset:256
    ds_read_b32 v210, v202 offset:512
    ds_read_b32 v211, v202 offset:768
    ds_read_b32 v212, v202 offset:1024
    ds_read_b32 v213, v202 offset:1280
    ds_read_b32 v214, v202 offset:1536
    ds_read_b32 v215, v202 offset:1792
    s_not_b64 exec, s[64:65]
    ds_read_b128 v[208:211], v203 offset:2048
    ds_read_b128 v[212:215], v203 offset:2080
    s_mov_b64 exec, -1
    s_waitcnt lgkmcnt(0)
    v_cvt_pk_bf16_f32 v8, v208, v209
    v_cvt_pk_bf16_f32 v9, v210, v211
    v_cvt_pk_bf16_f32 v10, v212, v213
    v_cvt_pk_bf16_f32 v11, v214, v215
    s_nop 1
    v_mfma_f32_32x32x16_bf16 v[44:59], v[8:11], v[4:7], 0
    s_mov_b32 s62, 0x358637bd
    s_nop 10
    v_add_f32 v12, s62, v52
    v_rcp_f32 v12, v12
    s_nop 0
    v_mul_f32 v44, v44, v12
    v_mul_f32 v45, v45, v12
    v_mul_f32 v46, v46, v12
    v_mul_f32 v47, v47, v12
    v_mul_f32 v48, v48, v12
    v_mul_f32 v49, v49, v12
    v_mul_f32 v50, v50, v12
    v_mul_f32 v51, v51, v12
    v_cvt_pk_bf16_f32 v16, v44, v45
    v_cvt_pk_bf16_f32 v17, v46, v47
    v_cvt_pk_bf16_f32 v18, v48, v49
    v_cvt_pk_bf16_f32 v19, v50, v51
    s_add_u32 s50, s49, 4194304
    buffer_store_dwordx4 v[16:19], v1, s[28:31], s50 offen sc1
    s_waitcnt vmcnt(0) lgkmcnt(0)
    s_barrier
    s_cmp_eq_u32 s22, 4
    s_cbranch_scc0 L_nof2_116
    s_lshr_b32 s48, s23, 1
    s_lshl_b32 s48, s48, 11
    s_and_b32 s49, s23, 1
    s_lshl_b32 s49, s49, 3
    s_add_u32 s49, s49, s24
    s_lshl_b32 s49, s49, 7
    s_add_u32 s48, s48, s49
    s_add_u32 s48, s48, 8552448
    v_mov_b32 v250, s25
    v_mov_b32 v251, 0
    s_mov_b64 exec, 1
    buffer_store_dword v250, v251, s[28:31], s48 offen sc1
    s_mov_b64 exec, -1
L_nof2_116:
    s_and_b32 s48, s2, 7
    s_lshr_b32 s49, s2, 3
    s_lshr_b32 s66, s48, 2
    s_and_b32 s67, s48, 3
    s_lshl_b32 s67, s67, 2
    s_and_b32 s50, s49, 3
    s_add_u32 s67, s67, s50
    s_lshr_b32 s68, s49, 2
    s_lshl_b32 s48, s67, 11
    s_add_u32 s48, s48, 8552448
    v_and_b32 v8, 15, v0
    v_lshlrev_b32 v8, 7, v8
    v_add_u32 v8, s48, v8
    v_bfe_u32 v2, v0, 2, 2
    v_and_b32 v3, 3, v0
    v_bfe_u32 v4, v0, 4, 1
    v_lshrrev_b32 v5, 5, v0
    v_lshlrev_b32 v5, 2, v5
    v_add_u32 v5, v5, v2
    v_lshlrev_b32 v5, 7, v5
    v_and_b32 v6, 1, v3
    v_lshlrev_b32 v6, 1, v6
    v_add_u32 v6, v6, v4
    v_and_b32 v7, 2, v2
    v_lshlrev_b32 v7, 1, v7
    v_xor_b32 v6, v6, v7
    v_lshlrev_b32 v6, 4, v6
    v_lshrrev_b32 v3, 1, v3
    v_lshlrev_b32 v3, 3, v3
    v_add3_u32 v5, v5, v6, v3
    v_add_u32 v194, 65536, v5
    s_lshl_b32 s48, s67, 2
    s_add_u32 s48, s48, s22
    s_lshl_b32 s49, s48, 15
    s_lshl_b32 s50, s66, 21
    s_add_u32 s49, s49, s50
    s_add_u32 s49, s49, 4194304
    v_lshlrev_b32 v1, 4, v0
    s_cmp_eq_u32 s68, 7
    s_cselect_b32 s51, 0, s68
    s_add_u32 s52, s51, 0
    s_cmp_ge_u32 s52, 7
    s_cselect_b32 s53, 7, 0
    s_sub_u32 s52, s52, s53
    s_cmp_ge_u32 s52, 3
    s_cselect_b32 s53, 1, 0
    s_add_u32 s86, s52, s53
    s_add_u32 s52, s51, 1
    s_cmp_ge_u32 s52, 7
    s_cselect_b32 s53, 7, 0
    s_sub_u32 s52, s52, s53
    s_cmp_ge_u32 s52, 3
    s_cselect_b32 s53, 1, 0
    s_add_u32 s87, s52, s53
    s_add_u32 s52, s51, 2
    s_cmp_ge_u32 s52, 7
    s_cselect_b32 s53, 7, 0
    s_sub_u32 s52, s52, s53
    s_cmp_ge_u32 s52, 3
    s_cselect_b32 s53, 1, 0
    s_add_u32 s88, s52, s53
    s_add_u32 s52, s51, 3
    s_cmp_ge_u32 s52, 7
    s_cselect_b32 s53, 7, 0
    s_sub_u32 s52, s52, s53
    s_cmp_ge_u32 s52, 3
    s_cselect_b32 s53, 1, 0
    s_add_u32 s89, s52, s53
    s_add_u32 s52, s51, 4
    s_cmp_ge_u32 s52, 7
    s_cselect_b32 s53, 7, 0
    s_sub_u32 s52, s52, s53
    s_cmp_ge_u32 s52, 3
    s_cselect_b32 s53, 1, 0
    s_add_u32 s92, s52, s53
    s_add_u32 s52, s51, 5
    s_cmp_ge_u32 s52, 7
    s_cselect_b32 s53, 7, 0
    s_sub_u32 s52, s52, s53
    s_cmp_ge_u32 s52, 3
    s_cselect_b32 s53, 1, 0
    s_add_u32 s93, s52, s53
    s_add_u32 s52, s51, 6
    s_cmp_ge_u32 s52, 7
    s_cselect_b32 s53, 7, 0
    s_sub_u32 s52, s52, s53
    s_cmp_ge_u32 s52, 3
    s_cselect_b32 s53, 1, 0
    s_add_u32 s94, s52, s53
    s_mov_b32 s100, 3
    s_lshl_b32 s52, s86, 12
    s_add_u32 s55, s52, s49
    s_lshl_b32 s52, s87, 12
    s_add_u32 s56, s52, s49
    s_lshl_b32 s52, s88, 12
    s_add_u32 s57, s52, s49
    s_lshl_b32 s52, s89, 12
    s_add_u32 s58, s52, s49
    s_lshl_b32 s52, s92, 12
    s_add_u32 s59, s52, s49
    s_lshl_b32 s52, s93, 12
    s_add_u32 s61, s52, s49
    s_lshl_b32 s52, s94, 12
    s_add_u32 s62, s52, s49
    s_lshl_b32 s52, s100, 12
    s_add_u32 s64, s52, s49
    s_lshr_b32 s52, s22, 1
    s_and_b32 s52, s52, 1
    s_lshl_b32 s52, s52, 3
    s_add_u32 s52, s52, 3
    s_lshl_b32 s52, s52, 7
    s_lshl_b32 s53, s67, 11
    s_add_u32 s52, s52, s53
    s_add_u32 s52, s52, 8552448
    v_mov_b32 v10, s52
    s_cmp_eq_u32 s22, 0
    s_cbranch_scc0 L_nof2poll_117
    s_mov_b64 exec, 0xf7f7
    s_mov_b32 s60, 0
L_f2_poll_118:
    buffer_load_dword v9, v8, s[28:31], 0 offen sc1
L_f2_chk_120:
    s_add_u32 s60, s60, 1
    s_cmp_gt_u32 s60, 2000000
    s_cbranch_scc1 L_f2_done_119
    s_waitcnt vmcnt(0)
    v_cmp_ne_u32 vcc, s25, v9
    s_nop 1
    s_cbranch_vccz L_f2_done_119
    s_sleep 1
    s_branch L_f2_poll_118
L_f2_done_119:
    s_waitcnt vmcnt(0)
    s_mov_b64 exec, -1
L_nof2poll_117:
    s_barrier
    s_cmp_ge_u32 s22, 4
    s_cbranch_scc1 L_fin
    buffer_load_dwordx4 v[12:15], v1, s[28:31], s55 offen offset:0 sc1
    buffer_load_dwordx4 v[16:19], v1, s[28:31], s55 offen offset:1024 sc1
    buffer_load_dwordx4 v[20:23], v1, s[28:31], s55 offen offset:2048 sc1
    buffer_load_dwordx4 v[24:27], v1, s[28:31], s55 offen offset:3072 sc1
    buffer_load_dwordx4 v[28:31], v1, s[28:31], s56 offen offset:0 sc1
    buffer_load_dwordx4 v[32:35], v1, s[28:31], s56 offen offset:1024 sc1
    buffer_load_dwordx4 v[36:39], v1, s[28:31], s56 offen offset:2048 sc1
    buffer_load_dwordx4 v[40:43], v1, s[28:31], s56 offen offset:3072 sc1
    buffer_load_dwordx4 v[44:47], v1, s[28:31], s57 offen offset:0 sc1
    buffer_load_dwordx4 v[48:51], v1, s[28:31], s57 offen offset:1024 sc1
    buffer_load_dwordx4 v[52:55], v1, s[28:31], s57 offen offset:2048 sc1
    buffer_load_dwordx4 v[56:59], v1, s[28:31], s57 offen offset:3072 sc1
    buffer_load_dwordx4 v[60:63], v1, s[28:31], s58 offen offset:0 sc1
    buffer_load_dwordx4 v[64:67], v1, s[28:31], s58 offen offset:1024 sc1
    buffer_load_dwordx4 v[68:71], v1, s[28:31], s58 offen offset:2048 sc1
    buffer_load_dwordx4 v[72:75], v1, s[28:31], s58 offen offset:3072 sc1
    s_mov_b32 s54, 0
    s_lshl_b32 s52, s86, 13
    v_add_u32 v192, s52, v194
    v_xor_b32 v193, 64, v192
    ds_read_b64_tr_b16 v[176:177], v192 offset:0
    ds_read_b64_tr_b16 v[178:179], v192 offset:1024
    ds_read_b64_tr_b16 v[180:181], v193 offset:0
    ds_read_b64_tr_b16 v[182:183], v193 offset:1024
    ds_read_b64_tr_b16 v[184:185], v192 offset:2048
    ds_read_b64_tr_b16 v[186:187], v192 offset:3072
    ds_read_b64_tr_b16 v[188:189], v193 offset:2048
    ds_read_b64_tr_b16 v[190:191], v193 offset:3072
    s_waitcnt vmcnt(15) lgkmcnt(4)
    buffer_load_dwordx4 v[76:79], v1, s[28:31], s59 offen offset:0 sc1
    v_mfma_f32_32x32x16_bf16 v[144:159], v[176:179], v[12:15], 0
    v_mfma_f32_32x32x16_bf16 v[160:175], v[180:183], v[12:15], 0
    ds_read_b64_tr_b16 v[176:177], v192 offset:4096
    ds_read_b64_tr_b16 v[178:179], v192 offset:5120
    ds_read_b64_tr_b16 v[180:181], v193 offset:4096
    ds_read_b64_tr_b16 v[182:183], v193 offset:5120
    s_waitcnt vmcnt(15) lgkmcnt(4)
    buffer_load_dwordx4 v[80:83], v1, s[28:31], s59 offen offset:1024 sc1
    v_mfma_f32_32x32x16_bf16 v[144:159], v[184:187], v[16:19], v[144:159]
    v_mfma_f32_32x32x16_bf16 v[160:175], v[188:191], v[16:19], v[160:175]
    ds_read_b64_tr_b16 v[184:185], v192 offset:6144
    ds_read_b64_tr_b16 v[186:187], v192 offset:7168
    ds_read_b64_tr_b16 v[188:189], v193 offset:6144
    ds_read_b64_tr_b16 v[190:191], v193 offset:7168
    s_waitcnt vmcnt(15) lgkmcnt(4)
    buffer_load_dwordx4 v[84:87], v1, s[28:31], s59 offen offset:2048 sc1
    v_mfma_f32_32x32x16_bf16 v[144:159], v[176:179], v[20:23], v[144:159]
    v_mfma_f32_32x32x16_bf16 v[160:175], v[180:183], v[20:23], v[160:175]
    s_lshl_b32 s52, s87, 13
    v_add_u32 v192, s52, v194
    v_xor_b32 v193, 64, v192
    ds_read_b64_tr_b16 v[176:177], v192 offset:0
    ds_read_b64_tr_b16 v[178:179], v192 offset:1024
    ds_read_b64_tr_b16 v[180:181], v193 offset:0
    ds_read_b64_tr_b16 v[182:183], v193 offset:1024
    s_waitcnt vmcnt(15) lgkmcnt(4)
    buffer_load_dwordx4 v[88:91], v1, s[28:31], s59 offen offset:3072 sc1
    v_mfma_f32_32x32x16_bf16 v[144:159], v[184:187], v[24:27], v[144:159]
    v_mfma_f32_32x32x16_bf16 v[160:175], v[188:191], v[24:27], v[160:175]
    ds_read_b64_tr_b16 v[184:185], v192 offset:2048
    ds_read_b64_tr_b16 v[186:187], v192 offset:3072
    ds_read_b64_tr_b16 v[188:189], v193 offset:2048
    ds_read_b64_tr_b16 v[190:191], v193 offset:3072
    s_waitcnt vmcnt(15) lgkmcnt(4)
    buffer_load_dwordx4 v[92:95], v1, s[28:31], s61 offen offset:0 sc1
    v_mfma_f32_32x32x16_bf16 v[144:159], v[176:179], v[28:31], v[144:159]
    v_mfma_f32_32x32x16_bf16 v[160:175], v[180:183], v[28:31], v[160:175]
    ds_read_b64_tr_b16 v[176:177], v192 offset:4096
    ds_read_b64_tr_b16 v[178:179], v192 offset:5120
    ds_read_b64_tr_b16 v[180:181], v193 offset:4096
    ds_read_b64_tr_b16 v[182:183], v193 offset:5120
    s_waitcnt vmcnt(15) lgkmcnt(4)
    buffer_load_dwordx4 v[96:99], v1, s[28:31], s61 offen offset:1024 sc1
    v_mfma_f32_32x32x16_bf16 v[144:159], v[184:187], v[32:35], v[144:159]
    v_mfma_f32_32x32x16_bf16 v[160:175], v[188:191], v[32:35], v[160:175]
    ds_read_b64_tr_b16 v[184:185], v192 offset:6144
    ds_read_b64_tr_b16 v[186:187], v192 offset:7168
    ds_read_b64_tr_b16 v[188:189], v193 offset:6144
    ds_read_b64_tr_b16 v[190:191], v193 offset:7168
    s_waitcnt vmcnt(15) lgkmcnt(4)
    buffer_load_dwordx4 v[100:103], v1, s[28:31], s61 offen offset:2048 sc1
    v_mfma_f32_32x32x16_bf16 v[144:159], v[176:179], v[36:39], v[144:159]
    v_mfma_f32_32x32x16_bf16 v[160:175], v[180:183], v[36:39], v[160:175]
    s_lshl_b32 s52, s88, 13
    v_add_u32 v192, s52, v194
    v_xor_b32 v193, 64, v192
    ds_read_b64_tr_b16 v[176:177], v192 offset:0
    ds_read_b64_tr_b16 v[178:179], v192 offset:1024
    ds_read_b64_tr_b16 v[180:181], v193 offset:0
    ds_read_b64_tr_b16 v[182:183], v193 offset:1024
    s_waitcnt vmcnt(15) lgkmcnt(4)
    buffer_load_dwordx4 v[104:107], v1, s[28:31], s61 offen offset:3072 sc1
    v_mfma_f32_32x32x16_bf16 v[144:159], v[184:187], v[40:43], v[144:159]
    v_mfma_f32_32x32x16_bf16 v[160:175], v[188:191], v[40:43], v[160:175]
    ds_read_b64_tr_b16 v[184:185], v192 offset:2048
    ds_read_b64_tr_b16 v[186:187], v192 offset:3072
    ds_read_b64_tr_b16 v[188:189], v193 offset:2048
    ds_read_b64_tr_b16 v[190:191], v193 offset:3072
    s_waitcnt vmcnt(15) lgkmcnt(4)
    buffer_load_dwordx4 v[108:111], v1, s[28:31], s62 offen offset:0 sc1
    v_mfma_f32_32x32x16_bf16 v[144:159], v[176:179], v[44:47], v[144:159]
    v_mfma_f32_32x32x16_bf16 v[160:175], v[180:183], v[44:47], v[160:175]
    ds_read_b64_tr_b16 v[176:177], v192 offset:4096
    ds_read_b64_tr_b16 v[178:179], v192 offset:5120
    ds_read_b64_tr_b16 v[180:181], v193 offset:4096
    ds_read_b64_tr_b16 v[182:183], v193 offset:5120
    s_waitcnt vmcnt(15) lgkmcnt(4)
    buffer_load_dwordx4 v[112:115], v1, s[28:31], s62 offen offset:1024 sc1
    v_mfma_f32_32x32x16_bf16 v[144:159], v[184:187], v[48:51], v[144:159]
    v_mfma_f32_32x32x16_bf16 v[160:175], v[188:191], v[48:51], v[160:175]
    ds_read_b64_tr_b16 v[184:185], v192 offset:6144
    ds_read_b64_tr_b16 v[186:187], v192 offset:7168
    ds_read_b64_tr_b16 v[188:189], v193 offset:6144
    ds_read_b64_tr_b16 v[190:191], v193 offset:7168
    s_waitcnt vmcnt(15) lgkmcnt(4)
    buffer_load_dwordx4 v[116:119], v1, s[28:31], s62 offen offset:2048 sc1
    v_mfma_f32_32x32x16_bf16 v[144:159], v[176:179], v[52:55], v[144:159]
    v_mfma_f32_32x32x16_bf16 v[160:175], v[180:183], v[52:55], v[160:175]
    s_lshl_b32 s52, s89, 13
    v_add_u32 v192, s52, v194
    v_xor_b32 v193, 64, v192
    ds_read_b64_tr_b16 v[176:177], v192 offset:0
    ds_read_b64_tr_b16 v[178:179], v192 offset:1024
    ds_read_b64_tr_b16 v[180:181], v193 offset:0
    ds_read_b64_tr_b16 v[182:183], v193 offset:1024
    s_waitcnt vmcnt(15) lgkmcnt(4)
    buffer_load_dwordx4 v[120:123], v1, s[28:31], s62 offen offset:3072 sc1
    v_mfma_f32_32x32x16_bf16 v[144:159], v[184:187], v[56:59], v[144:159]
    v_mfma_f32_32x32x16_bf16 v[160:175], v[188:191], v[56:59], v[160:175]
    ds_read_b64_tr_b16 v[184:185], v192 offset:2048
    ds_read_b64_tr_b16 v[186:187], v192 offset:3072
    ds_read_b64_tr_b16 v[188:189], v193 offset:2048
    ds_read_b64_tr_b16 v[190:191], v193 offset:3072
    s_waitcnt vmcnt(15) lgkmcnt(4)
    v_mfma_f32_32x32x16_bf16 v[144:159], v[176:179], v[60:63], v[144:159]
    v_mfma_f32_32x32x16_bf16 v[160:175], v[180:183], v[60:63], v[160:175]
    ds_read_b64_tr_b16 v[176:177], v192 offset:4096
    ds_read_b64_tr_b16 v[178:179], v192 offset:5120
    ds_read_b64_tr_b16 v[180:181], v193 offset:4096
    ds_read_b64_tr_b16 v[182:183], v193 offset:5120
    s_waitcnt vmcnt(14) lgkmcnt(4)
    v_mfma_f32_32x32x16_bf16 v[144:159], v[184:187], v[64:67], v[144:159]
    v_mfma_f32_32x32x16_bf16 v[160:175], v[188:191], v[64:67], v[160:175]
    ds_read_b64_tr_b16 v[184:185], v192 offset:6144
    ds_read_b64_tr_b16 v[186:187], v192 offset:7168
    ds_read_b64_tr_b16 v[188:189], v193 offset:6144
    ds_read_b64_tr_b16 v[190:191], v193 offset:7168
    s_waitcnt vmcnt(13) lgkmcnt(4)
    s_mov_b64 exec, 1
    buffer_load_dword v9, v10, s[28:31], 0 offen sc1
    s_mov_b64 exec, -1
    v_mfma_f32_32x32x16_bf16 v[144:159], v[176:179], v[68:71], v[144:159]
    v_mfma_f32_32x32x16_bf16 v[160:175], v[180:183], v[68:71], v[160:175]
    s_lshl_b32 s52, s92, 13
    v_add_u32 v192, s52, v194
    v_xor_b32 v193, 64, v192
    ds_read_b64_tr_b16 v[176:177], v192 offset:0
    ds_read_b64_tr_b16 v[178:179], v192 offset:1024
    ds_read_b64_tr_b16 v[180:181], v193 offset:0
    ds_read_b64_tr_b16 v[182:183], v193 offset:1024
    s_waitcnt vmcnt(13) lgkmcnt(4)
    v_mfma_f32_32x32x16_bf16 v[144:159], v[184:187], v[72:75], v[144:159]
    v_mfma_f32_32x32x16_bf16 v[160:175], v[188:191], v[72:75], v[160:175]
    ds_read_b64_tr_b16 v[184:185], v192 offset:2048
    ds_read_b64_tr_b16 v[186:187], v192 offset:3072
    ds_read_b64_tr_b16 v[188:189], v193 offset:2048
    ds_read_b64_tr_b16 v[190:191], v193 offset:3072
    s_waitcnt vmcnt(12) lgkmcnt(4)
    v_mfma_f32_32x32x16_bf16 v[144:159], v[176:179], v[76:79], v[144:159]
    v_mfma_f32_32x32x16_bf16 v[160:175], v[180:183], v[76:79], v[160:175]
    ds_read_b64_tr_b16 v[176:177], v192 offset:4096
    ds_read_b64_tr_b16 v[178:179], v192 offset:5120
    ds_read_b64_tr_b16 v[180:181], v193 offset:4096
    ds_read_b64_tr_b16 v[182:183], v193 offset:5120
    s_waitcnt vmcnt(11) lgkmcnt(4)
    v_mfma_f32_32x32x16_bf16 v[144:159], v[184:187], v[80:83], v[144:159]
    v_mfma_f32_32x32x16_bf16 v[160:175], v[188:191], v[80:83], v[160:175]
    ds_read_b64_tr_b16 v[184:185], v192 offset:6144
    ds_read_b64_tr_b16 v[186:187], v192 offset:7168
    ds_read_b64_tr_b16 v[188:189], v193 offset:6144
    ds_read_b64_tr_b16 v[190:191], v193 offset:7168
    s_waitcnt vmcnt(10) lgkmcnt(4)
    v_mfma_f32_32x32x16_bf16 v[144:159], v[176:179], v[84:87], v[144:159]
    v_mfma_f32_32x32x16_bf16 v[160:175], v[180:183], v[84:87], v[160:175]
    s_lshl_b32 s52, s93, 13
    v_add_u32 v192, s52, v194
    v_xor_b32 v193, 64, v192
    ds_read_b64_tr_b16 v[176:177], v192 offset:0
    ds_read_b64_tr_b16 v[178:179], v192 offset:1024
    ds_read_b64_tr_b16 v[180:181], v193 offset:0
    ds_read_b64_tr_b16 v[182:183], v193 offset:1024
    s_waitcnt vmcnt(9) lgkmcnt(4)
    v_mfma_f32_32x32x16_bf16 v[144:159], v[184:187], v[88:91], v[144:159]
    v_mfma_f32_32x32x16_bf16 v[160:175], v[188:191], v[88:91], v[160:175]
    ds_read_b64_tr_b16 v[184:185], v192 offset:2048
    ds_read_b64_tr_b16 v[186:187], v192 offset:3072
    ds_read_b64_tr_b16 v[188:189], v193 offset:2048
    ds_read_b64_tr_b16 v[190:191], v193 offset:3072
    s_waitcnt vmcnt(8) lgkmcnt(4)
    v_mfma_f32_32x32x16_bf16 v[144:159], v[176:179], v[92:95], v[144:159]
    v_mfma_f32_32x32x16_bf16 v[160:175], v[180:183], v[92:95], v[160:175]
    ds_read_b64_tr_b16 v[176:177], v192 offset:4096
    ds_read_b64_tr_b16 v[178:179], v192 offset:5120
    ds_read_b64_tr_b16 v[180:181], v193 offset:4096
    ds_read_b64_tr_b16 v[182:183], v193 offset:5120
    s_waitcnt vmcnt(7) lgkmcnt(4)
    v_mfma_f32_32x32x16_bf16 v[144:159], v[184:187], v[96:99], v[144:159]
    v_mfma_f32_32x32x16_bf16 v[160:175], v[188:191], v[96:99], v[160:175]
    ds_read_b64_tr_b16 v[184:185], v192 offset:6144
    ds_read_b64_tr_b16 v[186:187], v192 offset:7168
    ds_read_b64_tr_b16 v[188:189], v193 offset:6144
    ds_read_b64_tr_b16 v[190:191], v193 offset:7168
    s_waitcnt vmcnt(6) lgkmcnt(4)
    v_mfma_f32_32x32x16_bf16 v[144:159], v[176:179], v[100:103], v[144:159]
    v_mfma_f32_32x32x16_bf16 v[160:175], v[180:183], v[100:103], v[160:175]
    s_lshl_b32 s52, s94, 13
    v_add_u32 v192, s52, v194
    v_xor_b32 v193, 64, v192
    ds_read_b64_tr_b16 v[176:177], v192 offset:0
    ds_read_b64_tr_b16 v[178:179], v192 offset:1024
    ds_read_b64_tr_b16 v[180:181], v193 offset:0
    ds_read_b64_tr_b16 v[182:183], v193 offset:1024
    s_waitcnt vmcnt(5) lgkmcnt(4)
    v_mfma_f32_32x32x16_bf16 v[144:159], v[184:187], v[104:107], v[144:159]
    v_mfma_f32_32x32x16_bf16 v[160:175], v[188:191], v[104:107], v[160:175]
    ds_read_b64_tr_b16 v[184:185], v192 offset:2048
    ds_read_b64_tr_b16 v[186:187], v192 offset:3072
    ds_read_b64_tr_b16 v[188:189], v193 offset:2048
    ds_read_b64_tr_b16 v[190:191], v193 offset:3072
    s_waitcnt vmcnt(0) lgkmcnt(4)
    s_mov_b64 exec, 1
    v_cmp_ne_u32 vcc, s25, v9
    s_mov_b64 exec, -1
    s_nop 0
    s_cbranch_vccnz L_notyet_121
    buffer_load_dwordx4 v[124:127], v1, s[28:31], s64 offen offset:0 sc1
    buffer_load_dwordx4 v[128:131], v1, s[28:31], s64 offen offset:1024 sc1
    buffer_load_dwordx4 v[132:135], v1, s[28:31], s64 offen offset:2048 sc1
    buffer_load_dwordx4 v[136:139], v1, s[28:31], s64 offen offset:3072 sc1
    s_mov_b32 s54, 1
L_notyet_121:
    v_mfma_f32_32x32x16_bf16 v[144:159], v[176:179], v[108:111], v[144:159]
    v_mfma_f32_32x32x16_bf16 v[160:175], v[180:183], v[108:111], v[160:175]
    ds_read_b64_tr_b16 v[176:177], v192 offset:4096
    ds_read_b64_tr_b16 v[178:179], v192 offset:5120
    ds_read_b64_tr_b16 v[180:181], v193 offset:4096
    ds_read_b64_tr_b16 v[182:183], v193 offset:5120
    s_waitcnt lgkmcnt(4)
    v_mfma_f32_32x32x16_bf16 v[144:159], v[184:187], v[112:115], v[144:159]
    v_mfma_f32_32x32x16_bf16 v[160:175], v[188:191], v[112:115], v[160:175]
    ds_read_b64_tr_b16 v[184:185], v192 offset:6144
    ds_read_b64_tr_b16 v[186:187], v192 offset:7168
    ds_read_b64_tr_b16 v[188:189], v193 offset:6144
    ds_read_b64_tr_b16 v[190:191], v193 offset:7168
    s_waitcnt lgkmcnt(4)
    v_mfma_f32_32x32x16_bf16 v[144:159], v[176:179], v[116:119], v[144:159]
    v_mfma_f32_32x32x16_bf16 v[160:175], v[180:183], v[116:119], v[160:175]
    s_lshl_b32 s52, s100, 13
    v_add_u32 v192, s52, v194
    v_xor_b32 v193, 64, v192
    ds_read_b64_tr_b16 v[176:177], v192 offset:0
    ds_read_b64_tr_b16 v[178:179], v192 offset:1024
    ds_read_b64_tr_b16 v[180:181], v193 offset:0
    ds_read_b64_tr_b16 v[182:183], v193 offset:1024
    s_waitcnt lgkmcnt(4)
    v_mfma_f32_32x32x16_bf16 v[144:159], v[184:187], v[120:123], v[144:159]
    v_mfma_f32_32x32x16_bf16 v[160:175], v[188:191], v[120:123], v[160:175]
    s_cmp_eq_u32 s54, 1
    s_cbranch_scc1 L_slowok_122
    s_mov_b64 exec, 1
    s_mov_b32 s60, 0
L_f2s_poll_123:
    buffer_load_dword v9, v10, s[28:31], 0 offen sc1
L_f2s_chk_125:
    s_add_u32 s60, s60, 1
    s_cmp_gt_u32 s60, 2000000
    s_cbranch_scc1 L_f2s_done_124
    s_waitcnt vmcnt(0)
    v_cmp_ne_u32 vcc, s25, v9
    s_nop 1
    s_cbranch_vccz L_f2s_done_124
    s_sleep 1
    s_branch L_f2s_poll_123
L_f2s_done_124:
    s_waitcnt vmcnt(0)
    s_mov_b64 exec, -1
    buffer_load_dwordx4 v[124:127], v1, s[28:31], s64 offen offset:0 sc1
    buffer_load_dwordx4 v[128:131], v1, s[28:31], s64 offen offset:1024 sc1
    buffer_load_dwordx4 v[132:135], v1, s[28:31], s64 offen offset:2048 sc1
    buffer_load_dwordx4 v[136:139], v1, s[28:31], s64 offen offset:3072 sc1
    s_mov_b32 s54, 1
L_slowok_122:
    ds_read_b64_tr_b16 v[184:185], v192 offset:2048
    ds_read_b64_tr_b16 v[186:187], v192 offset:3072
    ds_read_b64_tr_b16 v[188:189], v193 offset:2048
    ds_read_b64_tr_b16 v[190:191], v193 offset:3072
    s_waitcnt vmcnt(3) lgkmcnt(4)
    v_mfma_f32_32x32x16_bf16 v[144:159], v[176:179], v[124:127], v[144:159]
    v_mfma_f32_32x32x16_bf16 v[160:175], v[180:183], v[124:127], v[160:175]
    ds_read_b64_tr_b16 v[176:177], v192 offset:4096
    ds_read_b64_tr_b16 v[178:179], v192 offset:5120
    ds_read_b64_tr_b16 v[180:181], v193 offset:4096
    ds_read_b64_tr_b16 v[182:183], v193 offset:5120
    s_waitcnt vmcnt(2) lgkmcnt(4)
    v_mfma_f32_32x32x16_bf16 v[144:159], v[184:187], v[128:131], v[144:159]
    v_mfma_f32_32x32x16_bf16 v[160:175], v[188:191], v[128:131], v[160:175]
    ds_read_b64_tr_b16 v[184:185], v192 offset:6144
    ds_read_b64_tr_b16 v[186:187], v192 offset:7168
    ds_read_b64_tr_b16 v[188:189], v193 offset:6144
    ds_read_b64_tr_b16 v[190:191], v193 offset:7168
    s_waitcnt vmcnt(1) lgkmcnt(4)
    v_mfma_f32_32x32x16_bf16 v[144:159], v[176:179], v[132:135], v[144:159]
    v_mfma_f32_32x32x16_bf16 v[160:175], v[180:183], v[132:135], v[160:175]
    s_waitcnt vmcnt(0) lgkmcnt(0)
    v_mfma_f32_32x32x16_bf16 v[144:159], v[184:187], v[136:139], v[144:159]
    v_mfma_f32_32x32x16_bf16 v[160:175], v[188:191], v[136:139], v[160:175]
    s_mov_b32 s40, s16
    s_mov_b32 s41, s17
    s_mov_b32 s42, 0x400000
    s_mov_b32 s43, 0x20000
    v_and_b32 v2, 31, v0
    s_lshl_b32 s49, s48, 5
    v_add_u32 v2, s49, v2
    v_lshlrev_b32 v2, 11, v2
    v_lshrrev_b32 v3, 5, v0
    v_lshlrev_b32 v3, 5, v3
    s_lshl_b32 s49, s66, 10
    s_lshl_b32 s50, s68, 7
    s_add_u32 s49, s49, s50
    v_add3_u32 v2, v2, v3, s49
    s_nop 3
    v_cvt_pk_bf16_f32 v12, v144, v145
    v_cvt_pk_bf16_f32 v13, v146, v147
    v_cvt_pk_bf16_f32 v14, v148, v149
    v_cvt_pk_bf16_f32 v15, v150, v151
    v_cvt_pk_bf16_f32 v16, v152, v153
    v_cvt_pk_bf16_f32 v17, v154, v155
    v_cvt_pk_bf16_f32 v18, v156, v157
    v_cvt_pk_bf16_f32 v19, v158, v159
    v_cvt_pk_bf16_f32 v20, v160, v161
    v_cvt_pk_bf16_f32 v21, v162, v163
    v_cvt_pk_bf16_f32 v22, v164, v165
    v_cvt_pk_bf16_f32 v23, v166, v167
    v_cvt_pk_bf16_f32 v24, v168, v169
    v_cvt_pk_bf16_f32 v25, v170, v171
    v_cvt_pk_bf16_f32 v26, v172, v173
    v_cvt_pk_bf16_f32 v27, v174, v175
    buffer_store_dwordx4 v[12:15], v2, s[40:43], 0 offen offset:0 nt
    buffer_store_dwordx4 v[16:19], v2, s[40:43], 0 offen offset:16 nt
    buffer_store_dwordx4 v[20:23], v2, s[40:43], 0 offen offset:64 nt
    buffer_store_dwordx4 v[24:27], v2, s[40:43], 0 offen offset:80 nt
L_fin:
L_end:
    s_endpgm
    .fill 2048, 4, 0xbf800000

.section .rodata,"a"
.p2align 6
.amdhsa_kernel concat_heads__linear_attn_block__sliding_block__prompt_kernel
  .amdhsa_next_free_vgpr 256
  .amdhsa_next_free_sgpr 102
  .amdhsa_accum_offset 256
  .amdhsa_group_segment_fixed_size 0
  .amdhsa_kernarg_size 72
  .amdhsa_user_sgpr_count 2
  .amdhsa_user_sgpr_kernarg_segment_ptr 1
  .amdhsa_system_sgpr_workgroup_id_x 1
.end_amdhsa_kernel
```
